```python
import torch

def _softmax(x, axis=-1):
    return torch.softmax(x, dim=axis)
def _gelu(x):
    return torch.nn.functional.gelu(x, approximate="tanh")
def _silu(x):
    return torch.nn.functional.silu(x)
def _sigmoid(x):
    return torch.sigmoid(x)
def _layernorm(x, axis=-1, eps=1e-5):
    m = x.mean(dim=axis, keepdim=True)
    v = x.var(dim=axis, keepdim=True, unbiased=False)
    return (x - m) / torch.sqrt(v + eps)
def _scatter_add(tgt, idx, src, axis=0):
    return tgt.clone().index_add_(axis, idx, src)
def _segment_sum(src, seg, n):
    out = torch.zeros((n,) + src.shape[1:], dtype=src.dtype)
    return out.index_add_(0, seg, src)
def _pad(x, pw):
    flat = tuple(v for pair in reversed(pw) for v in pair)
    return torch.nn.functional.pad(x, flat)

kernel_name = 'parallel_sum__sliding_block_cached__glu_gated_geglu__decode'

def setup_inputs():

    _w = (lambda a: (lambda t: t.to(torch.bfloat16) if t.is_floating_point() else t)(torch.as_tensor(a)))
    def _A_setup():
        B, Sq, D = 1, 1, 1024
        Hq, Hkv, Sk, Dh = 32, 4, 32768, 128
        assert Hq % Hkv == 0, (Hq, Hkv)
        return {
            "x": _w((lambda *s: torch.randn(*s, dtype=torch.bfloat16) * 0.05)(B, Sq, D)),
            "k_cache": _w((lambda *s: torch.randn(*s, dtype=torch.bfloat16) * 1.6)(B, Hkv, Sk, Dh)),
            "v_cache": _w((lambda *s: torch.randn(*s, dtype=torch.bfloat16) * 0.8)(B, Hkv, Sk, Dh)),
            "wq": _w((lambda *s: torch.randn(*s, dtype=torch.bfloat16) * 1.6)(D, Hq * Dh) * (D ** -0.5)),
            "wo": _w((lambda *s: torch.randn(*s, dtype=torch.bfloat16) * 0.8)(Hq * Dh, D) * ((Hq * Dh) ** -0.5)),
        }
    _A_in = _A_setup()

    def _B_setup():
        B, S, Dm, Df = 1, 1, 1024, 3584
        return {
            "x": _w((lambda *s: torch.randn(*s, dtype=torch.bfloat16) * 0.05)(B, S, Dm)),
            "w_gate": _w((lambda *s: torch.randn(*s, dtype=torch.bfloat16) * 0.8)(Dm, Df) * (Dm ** -0.5)),
            "w_up": _w((lambda *s: torch.randn(*s, dtype=torch.bfloat16) * 0.8)(Dm, Df) * (Dm ** -0.5)),
            "w_down": _w((lambda *s: torch.randn(*s, dtype=torch.bfloat16) * 0.8)(Df, Dm) * (Df ** -0.5)),
        }
    _B_in = _B_setup()

    return {
        "A_x": _A_in["x"],
        "A_k_cache": _A_in["k_cache"],
        "A_v_cache": _A_in["v_cache"],
        "A_wq": _A_in["wq"],
        "A_wo": _A_in["wo"],
        "B_x": _B_in["x"],
        "B_w_gate": _B_in["w_gate"],
        "B_w_up": _B_in["w_up"],
        "B_w_down": _B_in["w_down"],
    }

def reference(A_x, A_k_cache, A_v_cache, A_wq, A_wo, B_x, B_w_gate, B_w_up, B_w_down):
    def _A_ref(x, k_cache, v_cache, wq, wo):
        B, Sq, D = x.shape
        Hq, Dh = 32, 128
        Hkv, Sk = k_cache.shape[1], k_cache.shape[2]
        W = min(4096, max(256, Sk // 4))
        rep = Hq // Hkv
        q = (lambda x, *d: x.permute(*d))((x @ wq).reshape(B, Sq, Hq, Dh), 0, 2, 1, 3)
        k = (lambda x, n, axis: torch.repeat_interleave(x, n, dim=axis))(k_cache[:, :, Sk - W:, :], rep, axis=1)
        v = (lambda x, n, axis: torch.repeat_interleave(x, n, dim=axis))(v_cache[:, :, Sk - W:, :], rep, axis=1)
        scores = torch.einsum("bhqd,bhkd->bhqk", q, k) * (Dh ** -0.5)
        p = _softmax(scores, axis=-1)
        o = torch.einsum("bhqk,bhkd->bhqd", p, v)
        return (lambda x, *d: x.permute(*d))(o, 0, 2, 1, 3).reshape(B, Sq, Hq * Dh) @ wo

    def _B_ref(x, w_gate, w_up, w_down):
        g = torch.einsum("bsd,df->bsf", x, w_gate)
        u = torch.einsum("bsd,df->bsf", x, w_up)
        h = _gelu(g) * u
        return torch.einsum("bsf,fd->bsd", h, w_down)

    x = A_x
    xn = _layernorm(x, axis=-1)
    return x + _A_ref(xn, A_k_cache, A_v_cache, A_wq, A_wo) + _B_ref(xn, B_w_gate, B_w_up, B_w_down)
```

```asm
; @launch grid=(256,1,1) block=(512,1,1) lds=72896
.amdgcn_target "amdgcn-amd-amdhsa--gfx950"
.text
.globl parallel_sum__sliding_block_cached__glu_gated_geglu__decode_kernel
.p2align 8
.type parallel_sum__sliding_block_cached__glu_gated_geglu__decode_kernel,@function
parallel_sum__sliding_block_cached__glu_gated_geglu__decode_kernel:
    s_load_dwordx2 s[12:13], s[0:1], 24
    s_load_dwordx4 s[24:27], s[0:1], 48
    s_load_dwordx2 s[8:9], s[0:1], 0
    s_load_dwordx2 s[4:5], s[0:1], 88
    v_lshrrev_b32 v2, 6, v0
    v_and_b32 v1, 63, v0
    s_cmp_ge_u32 s2, 256
    s_cbranch_scc1 L_end
    v_readfirstlane_b32 s3, v2
    s_and_b32 s61, s2, 7
    s_lshl_b32 s61, s61, 2
    s_lshr_b32 s61, 0x32761054, s61
    s_and_b32 s61, s61, 7
    s_lshr_b32 s62, s2, 3
    v_lshrrev_b32 v6, 4, v1
    v_and_b32 v7, 15, v1
    v_lshlrev_b32 v4, 4, v1
    s_mov_b32 s10, 2048
    s_mov_b32 s11, 0x20000
    s_cmp_lt_u32 s3, 4
    s_cbranch_scc1 L_Cstub
    s_sub_u32 s46, s3, 4
    s_mov_b32 s15, 0x20000
    s_cmp_ge_u32 s62, 24
    s_cselect_b32 s54, 1, 0
    s_lshr_b32 s55, s62, 2
    s_min_u32 s55, s55, 6
    s_add_u32 s40, s54, 1
    s_lshr_b32 s56, s62, s40
    s_and_b32 s56, s56, 1
    s_lshl_b32 s40, s54, 1
    s_add_u32 s40, s40, 1
    s_and_b32 s57, s62, s40
    s_and_b32 s45, s61, 3
    s_mul_i32 s42, s45, 7
    s_add_u32 s42, s42, s55
    s_mov_b32 s40, s57
    s_mov_b32 s41, 32
    s_mov_b32 s43, 1
    s_lshl_b32 s45, s45, 3
    s_and_b32 s44, s62, 7
    s_add_u32 s44, s44, s45
    s_cmp_eq_u32 s54, 1
    s_cselect_b32 s40, 3, s40
    s_cselect_b32 s41, 16, s41
    s_cselect_b32 s42, s44, s42
    s_cselect_b32 s43, 0, s43
    s_lshr_b32 s44, s62, 2
    s_add_u32 s44, s44, s45
    s_and_b32 s45, s62, 3
    s_cmp_lt_u32 s61, 4
    s_cselect_b32 s40, s45, s40
    s_cselect_b32 s41, 12, s41
    s_cselect_b32 s42, s44, s42
    s_cselect_b32 s43, 0, s43
    s_cmp_eq_u32 s43, 0
    s_cselect_b32 s47, 0x2000, s10
    s_cselect_b32 s14, 0x800000, s10
    s_cmp_eq_u32 s43, 1
    s_cselect_b32 s47, 0x1c00, s47
    s_cselect_b32 s14, 0x700000, s14
    s_lshl_b32 s40, s40, 2
    s_add_u32 s40, s40, s46
    s_mul_i32 s40, s40, s41
    s_lshl_b32 s49, s40, 3
    s_mul_i32 s51, s40, s47
    s_lshl_b32 s51, s51, 2
    s_lshl_b32 s42, s42, 8
    s_add_u32 s51, s51, s42
    s_mul_i32 s41, s41, s47
    v_mul_u32_u24 v2, s41, v6
    v_lshl_add_u32 v2, v7, 4, v2
    s_cmp_eq_u32 s56, 1
    s_waitcnt lgkmcnt(0)
    s_cselect_b32 s44, s26, s24
    s_cselect_b32 s45, s27, s25
    s_cmp_eq_u32 s43, 1
    s_cselect_b32 s12, s44, s12
    s_cselect_b32 s13, s45, s13
    buffer_load_dwordx4 v[64:67], v2, s[12:15], s51 offen nt
    s_add_u32 s51, s51, s47
    buffer_load_dwordx4 v[68:71], v2, s[12:15], s51 offen nt
    s_add_u32 s51, s51, s47
    buffer_load_dwordx4 v[72:75], v2, s[12:15], s51 offen nt
    s_add_u32 s51, s51, s47
    buffer_load_dwordx4 v[76:79], v2, s[12:15], s51 offen nt
    s_add_u32 s51, s51, s47
    buffer_load_dwordx4 v[80:83], v2, s[12:15], s51 offen nt
    s_cmp_eq_u32 s43, 1
    s_cbranch_scc1 L_SF
    s_cmp_ge_u32 s61, 4
    s_cbranch_scc1 L_SM
    s_branch L_SA
L_Cstub:
    s_setprio 3
    s_cmp_lg_u32 s3, 0
    s_cbranch_scc1 L_Cn0
    s_mov_b32 s6, 0x10000000
    s_mov_b32 s7, 0x20000
    s_waitcnt lgkmcnt(0)
    buffer_load_dwordx4 v[16:19], v4, s[8:11], 0 offen
    buffer_load_dwordx4 v[20:23], v4, s[8:11], 0 offen offset:1024
    buffer_load_dwordx2 v[24:25], off, s[4:7], 0 sc0 sc1
    s_branch L_C0
L_SA:
    v_lshlrev_b32 v60, 2, v1
    buffer_load_dword v32, v60, s[8:11], s49 offen
    s_mov_b32 s6, 0x10000000
    s_mov_b32 s7, 0x20000
    s_mov_b32 s10, 2048
    s_mov_b32 s11, 0x20000
    s_lshl_b32 s60, s61, 5
    s_add_u32 s60, s60, s62
    v_mov_b32 v8, 65536
    v_mov_b32 v9, 1
    s_load_dwordx2 s[16:17], s[0:1], 32
    s_load_dwordx2 s[20:21], s[0:1], 8
    s_load_dwordx2 s[24:25], s[0:1], 16
    s_mov_b32 s18, 0x800000
    s_mov_b32 s22, 0x2000000
    s_mov_b32 s23, 0x20000
    s_mov_b32 s26, 0x2000000
    s_mov_b32 s27, 0x20000
    s_mov_b32 s19, 0x20000
    v_mov_b32 v5, 0x3ff
    v_mul_u32_u24 v3, 32768, v6
    v_lshl_or_b32 v3, v7, 4, v3
    s_and_b32 s40, s62, 1
    s_lshl_b32 s40, s40, 10
    s_lshl_b32 s41, s46, 8
    s_add_u32 s40, s40, s41
    s_lshr_b32 s41, s60, 1
    s_lshl_b32 s52, s41, 17
    s_add_u32 s52, s52, s40
    v_xor_b32 v10, v7, v6
    v_lshlrev_b32 v10, 4, v10
    v_lshl_or_b32 v10, v6, 8, v10
    v_lshlrev_b32 v11, 1, v6
    v_xor_b32 v11, v7, v11
    v_lshlrev_b32 v11, 4, v11
    v_lshl_or_b32 v11, v6, 8, v11
    s_lshl_b32 s50, s61, 23
    s_lshl_b32 s40, s62, 15
    s_add_u32 s50, s50, s40
    s_lshl_b32 s54, s46, 13
    s_add_u32 s50, s50, s54
    s_add_u32 s50, s50, 7340032
    s_add_u32 s55, s54, 32768
    s_lshl_b32 s53, s62, 10
    v_and_b32 v60, 8, v7
    v_cmp_eq_u32 vcc, 0, v60
    v_mov_b32 v60, 0x0c0c0302
    v_mov_b32 v61, 0x0c0c0100
    v_cndmask_b32 v60, v60, v61, vcc
    v_and_b32 v61, 1, v7
    v_lshlrev_b32 v61, 4, v61
    v_alignbit_b32 v60, v60, v60, v61
    v_bfe_u32 v62, v7, 1, 2
    v_mov_b32 v63, 0x0c0c0c0c
    v_cmp_eq_u32 vcc, 0, v62
    s_nop 1
    v_cndmask_b32 v48, v63, v60, vcc
    v_cmp_eq_u32 vcc, 1, v62
    s_nop 1
    v_cndmask_b32 v49, v63, v60, vcc
    v_cmp_eq_u32 vcc, 2, v62
    s_nop 1
    v_cndmask_b32 v50, v63, v60, vcc
    v_cmp_eq_u32 vcc, 3, v62
    s_nop 1
    v_cndmask_b32 v51, v63, v60, vcc
    s_waitcnt lgkmcnt(0)
    s_barrier
    s_waitcnt vmcnt(5)
    s_add_u32 s51, s51, s47
    buffer_load_dwordx4 v[84:87], v2, s[12:15], s51 offen nt
    s_waitcnt vmcnt(5)
    s_add_u32 s51, s51, s47
    buffer_load_dwordx4 v[88:91], v2, s[12:15], s51 offen nt
    s_waitcnt vmcnt(5)
    s_add_u32 s51, s51, s47
    buffer_load_dwordx4 v[92:95], v2, s[12:15], s51 offen nt
    s_waitcnt vmcnt(5)
    s_add_u32 s51, s51, s47
    buffer_load_dwordx4 v[96:99], v2, s[12:15], s51 offen nt
    s_waitcnt vmcnt(5)
    s_add_u32 s51, s51, s47
    buffer_load_dwordx4 v[100:103], v2, s[12:15], s51 offen nt
    s_waitcnt vmcnt(4)
    s_add_u32 s51, s51, s47
    buffer_load_dwordx4 v[104:107], v2, s[12:15], s51 offen nt
    s_mov_b32 s44, 0
L_tg1:
    ds_read_b128 v[60:63], v8 offset:7312
    s_waitcnt lgkmcnt(0)
    v_readfirstlane_b32 s45, v62
    v_readfirstlane_b32 s38, v60
    v_readfirstlane_b32 s39, v61
    s_bitcmp1_b32 s45, 0
    s_cbranch_scc1 L_tg1_ok
    s_sleep 1
    s_add_u32 s44, s44, 1
    s_cmp_lt_u32 s44, 1600000
    s_cbranch_scc1 L_tg1
L_tg1_ok:
    s_and_b32 s30, s38, 0xfff
    s_bfe_u32 s31, s38, 0xc000c
    s_and_b32 s32, s39, 0xfff
    s_bfe_u32 s33, s39, 0xc000c
    v_and_b32 v62, 0xffff0000, v62
    v_lshlrev_b32 v34, 16, v32
    v_and_b32 v35, 0xffff0000, v32
    v_sub_f32 v34, v34, v62
    v_sub_f32 v35, v35, v62
    v_cvt_pk_bf16_f32 v36, v34, v35
    v_lshlrev_b32 v34, 16, v36
    v_and_b32 v35, 0xffff0000, v36
    v_mul_f32 v34, v34, v63
    v_mul_f32 v35, v35, v63
    v_cvt_pk_bf16_f32 v36, v34, v35
    s_lshl_b32 s40, s46, 8
    s_add_u32 s40, s40, 65536
    v_lshl_add_u32 v37, v1, 2, s40
    ds_write_b32 v37, v36
    v_mul_u32_u24 v37, 24, v6
    v_add_u32 v37, s40, v37
    ds_read_b64 v[16:17], v37 offset:0
    ds_read_b64 v[18:19], v37 offset:8
    ds_read_b64 v[20:21], v37 offset:16
    s_lshl_b32 s40, s46, 9
    s_add_u32 s40, s40, 66560
    v_lshl_add_u32 v33, v7, 1, v6
    v_lshl_add_u32 v33, v33, 4, s40
    s_waitcnt lgkmcnt(0)
    v_perm_b32 v40, v16, v16, v48
    v_perm_b32 v41, v16, v16, v49
    v_perm_b32 v42, v16, v16, v50
    v_perm_b32 v43, v16, v16, v51
    s_nop 1
    v_mfma_f32_16x16x32_bf16 v[56:59], v[40:43], v[64:67], 0
    v_mfma_f32_16x16x32_bf16 v[52:55], v[40:43], v[68:71], 0
    v_perm_b32 v44, v17, v17, v48
    v_perm_b32 v45, v17, v17, v49
    v_perm_b32 v46, v17, v17, v50
    v_perm_b32 v47, v17, v17, v51
    s_nop 1
    v_mfma_f32_16x16x32_bf16 v[56:59], v[44:47], v[72:75], v[56:59]
    s_waitcnt vmcnt(4)
    s_add_u32 s51, s51, s47
    buffer_load_dwordx4 v[108:111], v2, s[12:15], s51 offen nt
    v_mfma_f32_16x16x32_bf16 v[52:55], v[44:47], v[76:79], v[52:55]
    v_perm_b32 v40, v18, v18, v48
    v_perm_b32 v41, v18, v18, v49
    v_perm_b32 v42, v18, v18, v50
    v_perm_b32 v43, v18, v18, v51
    s_nop 1
    v_mfma_f32_16x16x32_bf16 v[56:59], v[40:43], v[80:83], v[56:59]
    v_mfma_f32_16x16x32_bf16 v[52:55], v[40:43], v[84:87], v[52:55]
    s_waitcnt vmcnt(4)
    s_add_u32 s53, s53, 1024
    s_and_b32 s53, s53, 0x1c00
    s_bfe_u32 s40, s53, 0x2000a
    s_lshl_b32 s40, s40, 6
    s_or_b32 s40, s40, s53
    v_xor_b32 v12, s40, v10
    s_add_u32 m0, s53, s54
    s_nop 0
    buffer_load_dwordx4 v12, s[20:23], s50 offen nt lds
    v_perm_b32 v44, v19, v19, v48
    v_perm_b32 v45, v19, v19, v49
    v_perm_b32 v46, v19, v19, v50
    v_perm_b32 v47, v19, v19, v51
    s_nop 1
    v_mfma_f32_16x16x32_bf16 v[56:59], v[44:47], v[88:91], v[56:59]
    v_mfma_f32_16x16x32_bf16 v[52:55], v[44:47], v[92:95], v[52:55]
    s_waitcnt vmcnt(4)
    s_add_u32 s53, s53, 1024
    s_and_b32 s53, s53, 0x1c00
    s_bfe_u32 s40, s53, 0x2000a
    s_lshl_b32 s40, s40, 6
    s_or_b32 s40, s40, s53
    v_xor_b32 v13, s40, v10
    s_add_u32 m0, s53, s54
    s_nop 0
    buffer_load_dwordx4 v13, s[20:23], s50 offen nt lds
    v_perm_b32 v40, v20, v20, v48
    v_perm_b32 v41, v20, v20, v49
    v_perm_b32 v42, v20, v20, v50
    v_perm_b32 v43, v20, v20, v51
    s_nop 1
    v_mfma_f32_16x16x32_bf16 v[56:59], v[40:43], v[96:99], v[56:59]
    s_waitcnt vmcnt(4)
    s_add_u32 s53, s53, 1024
    s_and_b32 s53, s53, 0x1c00
    s_bfe_u32 s40, s53, 0x2000a
    s_lshl_b32 s40, s40, 6
    s_or_b32 s40, s40, s53
    v_xor_b32 v12, s40, v10
    s_add_u32 m0, s53, s54
    s_nop 0
    buffer_load_dwordx4 v12, s[20:23], s50 offen nt lds
    v_mfma_f32_16x16x32_bf16 v[52:55], v[40:43], v[100:103], v[52:55]
    s_waitcnt vmcnt(4)
    s_add_u32 s53, s53, 1024
    s_and_b32 s53, s53, 0x1c00
    s_bfe_u32 s40, s53, 0x2000a
    s_lshl_b32 s40, s40, 6
    s_or_b32 s40, s40, s53
    v_xor_b32 v13, s40, v10
    s_add_u32 m0, s53, s54
    s_nop 0
    buffer_load_dwordx4 v13, s[20:23], s50 offen nt lds
    v_perm_b32 v44, v21, v21, v48
    v_perm_b32 v45, v21, v21, v49
    v_perm_b32 v46, v21, v21, v50
    v_perm_b32 v47, v21, v21, v51
    s_nop 1
    v_mfma_f32_16x16x32_bf16 v[56:59], v[44:47], v[104:107], v[56:59]
    s_waitcnt vmcnt(4)
    s_add_u32 s53, s53, 1024
    s_and_b32 s53, s53, 0x1c00
    s_bfe_u32 s40, s53, 0x2000a
    s_lshl_b32 s40, s40, 6
    s_or_b32 s40, s40, s53
    v_xor_b32 v12, s40, v10
    s_add_u32 m0, s53, s54
    s_nop 0
    buffer_load_dwordx4 v12, s[20:23], s50 offen nt lds
    v_mfma_f32_16x16x32_bf16 v[52:55], v[44:47], v[108:111], v[52:55]
    s_nop 7
    v_permlane32_swap_b32 v52, v53
    v_permlane32_swap_b32 v54, v55
    v_add_f32 v56, v56, v53
    v_add_f32 v58, v58, v55
    v_permlane32_swap_b32 v53, v52
    v_permlane32_swap_b32 v55, v54
    v_add_f32 v57, v57, v52
    v_add_f32 v59, v59, v54
    s_mov_b32 exec_hi, 0
    ds_write_b128 v33, v[56:59]
    s_mov_b64 exec, 1
    ds_add_u32 v8, v9 offset:7296
    s_mov_b64 exec, -1
    s_waitcnt vmcnt(4)
    s_add_u32 s53, s53, 1024
    s_and_b32 s53, s53, 0x1c00
    s_bfe_u32 s40, s53, 0x2000a
    s_lshl_b32 s40, s40, 6
    s_or_b32 s40, s40, s53
    v_xor_b32 v13, s40, v10
    s_add_u32 m0, s53, s54
    s_nop 0
    buffer_load_dwordx4 v13, s[20:23], s50 offen nt lds
    s_waitcnt vmcnt(4)
    s_add_u32 s53, s53, 1024
    s_and_b32 s53, s53, 0x1c00
    s_bfe_u32 s40, s53, 0x2000a
    s_lshl_b32 s40, s40, 6
    s_or_b32 s40, s40, s53
    v_xor_b32 v12, s40, v10
    s_add_u32 m0, s53, s54
    s_nop 0
    buffer_load_dwordx4 v12, s[20:23], s50 offen nt lds
    s_waitcnt vmcnt(4)
    s_add_u32 s53, s53, 1024
    s_and_b32 s53, s53, 0x1c00
    s_bfe_u32 s40, s53, 0x2000a
    s_lshl_b32 s40, s40, 6
    s_or_b32 s40, s40, s53
    v_xor_b32 v13, s40, v10
    s_add_u32 m0, s53, s54
    s_nop 0
    buffer_load_dwordx4 v13, s[20:23], s50 offen nt lds
    s_waitcnt vmcnt(4)
    s_add_u32 s53, s53, 1024
    s_and_b32 s53, s53, 0x1c00
    s_bfe_u32 s40, s53, 0x1000a
    s_lshl_b32 s40, s40, 7
    s_or_b32 s40, s40, s53
    v_xor_b32 v12, s40, v11
    s_add_u32 m0, s53, s55
    s_nop 0
    buffer_load_dwordx4 v12, s[24:27], s50 offen nt lds
    s_waitcnt vmcnt(4)
    s_add_u32 s53, s53, 1024
    s_and_b32 s53, s53, 0x1c00
    s_bfe_u32 s40, s53, 0x1000a
    s_lshl_b32 s40, s40, 7
    s_or_b32 s40, s40, s53
    v_xor_b32 v13, s40, v11
    s_add_u32 m0, s53, s55
    s_nop 0
    buffer_load_dwordx4 v13, s[24:27], s50 offen nt lds
    s_waitcnt vmcnt(4)
    s_add_u32 s53, s53, 1024
    s_and_b32 s53, s53, 0x1c00
    s_bfe_u32 s40, s53, 0x1000a
    s_lshl_b32 s40, s40, 7
    s_or_b32 s40, s40, s53
    v_xor_b32 v12, s40, v11
    s_add_u32 m0, s53, s55
    s_nop 0
    buffer_load_dwordx4 v12, s[24:27], s50 offen nt lds
    s_waitcnt vmcnt(4)
    s_add_u32 s53, s53, 1024
    s_and_b32 s53, s53, 0x1c00
    s_bfe_u32 s40, s53, 0x1000a
    s_lshl_b32 s40, s40, 7
    s_or_b32 s40, s40, s53
    v_xor_b32 v13, s40, v11
    s_add_u32 m0, s53, s55
    s_nop 0
    buffer_load_dwordx4 v13, s[24:27], s50 offen nt lds
    s_waitcnt vmcnt(4)
    s_add_u32 s53, s53, 1024
    s_and_b32 s53, s53, 0x1c00
    s_bfe_u32 s40, s53, 0x1000a
    s_lshl_b32 s40, s40, 7
    s_or_b32 s40, s40, s53
    v_xor_b32 v12, s40, v11
    s_add_u32 m0, s53, s55
    s_nop 0
    buffer_load_dwordx4 v12, s[24:27], s50 offen nt lds
    s_mov_b64 exec, 1
    ds_add_u32 v8, v9 offset:7300
    s_mov_b64 exec, -1
    s_mov_b64 exec, 1
    ds_add_u32 v8, v9 offset:7336
    s_mov_b64 exec, -1
    s_waitcnt vmcnt(4)
    s_add_u32 s53, s53, 1024
    s_and_b32 s53, s53, 0x1c00
    s_bfe_u32 s40, s53, 0x1000a
    s_lshl_b32 s40, s40, 7
    s_or_b32 s40, s40, s53
    v_xor_b32 v13, s40, v11
    s_add_u32 m0, s53, s55
    s_nop 0
    buffer_load_dwordx4 v13, s[24:27], s50 offen nt lds
    s_waitcnt vmcnt(4)
    s_add_u32 s53, s53, 1024
    s_and_b32 s53, s53, 0x1c00
    s_bfe_u32 s40, s53, 0x1000a
    s_lshl_b32 s40, s40, 7
    s_or_b32 s40, s40, s53
    v_xor_b32 v12, s40, v11
    s_add_u32 m0, s53, s55
    s_nop 0
    buffer_load_dwordx4 v12, s[24:27], s50 offen nt lds
    s_waitcnt vmcnt(4)
    s_add_u32 s53, s53, 1024
    s_and_b32 s53, s53, 0x1c00
    s_bfe_u32 s40, s53, 0x1000a
    s_lshl_b32 s40, s40, 7
    s_or_b32 s40, s40, s53
    v_xor_b32 v13, s40, v11
    s_add_u32 m0, s53, s55
    s_nop 0
    buffer_load_dwordx4 v13, s[24:27], s50 offen nt lds
    s_waitcnt vmcnt(4)
    buffer_load_dwordx4 v[64:67], v3, s[16:19], s52 offen offset:0 nt
    s_waitcnt vmcnt(4)
    buffer_load_dwordx4 v[68:71], v3, s[16:19], s52 offen offset:2048 nt
    s_waitcnt vmcnt(4)
    s_add_u32 s52, s52, 4096
    buffer_load_dwordx4 v[72:75], v3, s[16:19], s52 offen offset:0 nt
    s_waitcnt vmcnt(4)
    buffer_load_dwordx4 v[76:79], v3, s[16:19], s52 offen offset:2048 nt
    s_waitcnt vmcnt(4)
    s_add_u32 s52, s52, 4096
    buffer_load_dwordx4 v[80:83], v3, s[16:19], s52 offen offset:0 nt
    s_mov_b64 exec, 1
    ds_add_u32 v8, v9 offset:7304
    s_mov_b64 exec, -1
    s_waitcnt vmcnt(4)
    buffer_load_dwordx4 v[84:87], v3, s[16:19], s52 offen offset:2048 nt
    s_waitcnt vmcnt(4)
    s_add_u32 s52, s52, 4096
    buffer_load_dwordx4 v[88:91], v3, s[16:19], s52 offen offset:0 nt
    s_waitcnt vmcnt(4)
    buffer_load_dwordx4 v[92:95], v3, s[16:19], s52 offen offset:2048 nt
    s_waitcnt vmcnt(4)
    s_add_u32 s52, s52, 4096
    buffer_load_dwordx4 v[96:99], v3, s[16:19], s52 offen offset:0 nt
    s_waitcnt vmcnt(4)
    buffer_load_dwordx4 v[100:103], v3, s[16:19], s52 offen offset:2048 nt
    s_waitcnt vmcnt(4)
    s_add_u32 s52, s52, 4096
    buffer_load_dwordx4 v[104:107], v3, s[16:19], s52 offen offset:0 nt
    s_mov_b64 exec, 1
    ds_add_u32 v8, v9 offset:7340
    s_mov_b64 exec, -1
    s_waitcnt vmcnt(4)
    buffer_load_dwordx4 v[108:111], v3, s[16:19], s52 offen offset:2048 nt
    s_waitcnt vmcnt(4)
    s_add_u32 s52, s52, 4096
    buffer_load_dwordx4 v[112:115], v3, s[16:19], s52 offen offset:0 nt
    s_waitcnt vmcnt(4)
    buffer_load_dwordx4 v[116:119], v3, s[16:19], s52 offen offset:2048 nt
    s_mov_b64 exec, 1
    ds_add_u32 v8, v9 offset:7340
    s_mov_b64 exec, -1
    s_waitcnt vmcnt(4)
    s_add_u32 s52, s52, 4096
    buffer_load_dwordx4 v[120:123], v3, s[16:19], s52 offen offset:0 nt
    s_waitcnt vmcnt(4)
    buffer_load_dwordx4 v[124:127], v3, s[16:19], s52 offen offset:2048 nt
    v_and_b32 v11, 3, v7
    v_lshl_add_u32 v11, v11, 1, v6
    v_lshlrev_b32 v11, 4, v11
    v_lshrrev_b32 v12, 2, v7
    v_lshl_or_b32 v11, v12, 14, v11
    s_and_b32 s50, s60, 1
    s_lshl_b32 s50, s50, 2
    s_add_u32 s50, s50, s46
    s_lshl_b32 s50, s50, 16
    s_lshr_b32 s41, s60, 1
    s_lshl_b32 s41, s41, 7
    s_add_u32 s50, s50, s41
    s_add_u32 s50, s50, 1572864
    v_lshlrev_b32 v12, 5, v6
    v_add_u32 v12, 72704, v12
    s_mov_b32 s44, 0
L_lw2:
    ds_read_b32 v13, v8 offset:7332
    ds_read_b128 v[16:19], v12
    ds_read_b128 v[20:23], v12 offset:16
    s_waitcnt lgkmcnt(0)
    v_readfirstlane_b32 s45, v13
    s_nop 0
    s_cmp_ge_u32 s45, 2
    s_cbranch_scc1 L_lw2_ok
    s_add_u32 s44, s44, 1
    s_cmp_lt_u32 s44, 1600000
    s_cbranch_scc1 L_lw2
L_lw2_ok:
    v_perm_b32 v40, v16, v16, v48
    v_perm_b32 v41, v16, v16, v49
    v_perm_b32 v42, v16, v16, v50
    v_perm_b32 v43, v16, v16, v51
    s_nop 1
    v_mfma_f32_16x16x32_bf16 v[56:59], v[40:43], v[64:67], 0
    v_perm_b32 v44, v17, v17, v48
    v_perm_b32 v45, v17, v17, v49
    v_perm_b32 v46, v17, v17, v50
    v_perm_b32 v47, v17, v17, v51
    v_mfma_f32_16x16x32_bf16 v[52:55], v[40:43], v[68:71], 0
    s_nop 0
    v_mfma_f32_16x16x32_bf16 v[56:59], v[44:47], v[72:75], v[56:59]
    v_perm_b32 v40, v18, v18, v48
    v_perm_b32 v41, v18, v18, v49
    v_perm_b32 v42, v18, v18, v50
    v_perm_b32 v43, v18, v18, v51
    v_mfma_f32_16x16x32_bf16 v[52:55], v[44:47], v[76:79], v[52:55]
    s_nop 0
    v_mfma_f32_16x16x32_bf16 v[56:59], v[40:43], v[80:83], v[56:59]
    v_perm_b32 v44, v19, v19, v48
    v_perm_b32 v45, v19, v19, v49
    v_perm_b32 v46, v19, v19, v50
    v_perm_b32 v47, v19, v19, v51
    v_mfma_f32_16x16x32_bf16 v[52:55], v[40:43], v[84:87], v[52:55]
    s_nop 0
    v_mfma_f32_16x16x32_bf16 v[56:59], v[44:47], v[88:91], v[56:59]
    v_perm_b32 v40, v20, v20, v48
    v_perm_b32 v41, v20, v20, v49
    v_perm_b32 v42, v20, v20, v50
    v_perm_b32 v43, v20, v20, v51
    v_mfma_f32_16x16x32_bf16 v[52:55], v[44:47], v[92:95], v[52:55]
    s_waitcnt vmcnt(7)
    v_mfma_f32_16x16x32_bf16 v[56:59], v[40:43], v[96:99], v[56:59]
    v_perm_b32 v44, v21, v21, v48
    v_perm_b32 v45, v21, v21, v49
    v_perm_b32 v46, v21, v21, v50
    v_perm_b32 v47, v21, v21, v51
    s_waitcnt vmcnt(6)
    v_mfma_f32_16x16x32_bf16 v[52:55], v[40:43], v[100:103], v[52:55]
    s_waitcnt vmcnt(5)
    v_mfma_f32_16x16x32_bf16 v[56:59], v[44:47], v[104:107], v[56:59]
    v_perm_b32 v40, v22, v22, v48
    v_perm_b32 v41, v22, v22, v49
    v_perm_b32 v42, v22, v22, v50
    v_perm_b32 v43, v22, v22, v51
    s_waitcnt vmcnt(4)
    v_mfma_f32_16x16x32_bf16 v[52:55], v[44:47], v[108:111], v[52:55]
    s_waitcnt vmcnt(3)
    v_mfma_f32_16x16x32_bf16 v[56:59], v[40:43], v[112:115], v[56:59]
    v_perm_b32 v44, v23, v23, v48
    v_perm_b32 v45, v23, v23, v49
    v_perm_b32 v46, v23, v23, v50
    v_perm_b32 v47, v23, v23, v51
    s_waitcnt vmcnt(2)
    v_mfma_f32_16x16x32_bf16 v[52:55], v[40:43], v[116:119], v[52:55]
    s_waitcnt vmcnt(1)
    v_mfma_f32_16x16x32_bf16 v[56:59], v[44:47], v[120:123], v[56:59]
    s_waitcnt vmcnt(0)
    v_mfma_f32_16x16x32_bf16 v[52:55], v[44:47], v[124:127], v[52:55]
    s_nop 7
    v_permlane32_swap_b32 v52, v53
    v_permlane32_swap_b32 v54, v55
    v_add_f32 v56, v56, v53
    v_add_f32 v58, v58, v55
    v_permlane32_swap_b32 v53, v52
    v_permlane32_swap_b32 v55, v54
    v_add_f32 v57, v57, v52
    v_add_f32 v59, v59, v54
    v_add_u32 v56, 512, v56
    v_add_u32 v57, 512, v57
    v_add_u32 v58, 512, v58
    v_add_u32 v59, 512, v59
    v_bfi_b32 v56, v5, s30, v56
    v_bfi_b32 v57, v5, s31, v57
    v_bfi_b32 v58, v5, s32, v58
    v_bfi_b32 v59, v5, s33, v59
    s_mov_b32 exec_hi, 0
    buffer_store_dwordx4 v[56:59], v11, s[4:7], s50 offen sc1
    s_barrier
    s_branch L_fin
L_SF:
    v_lshlrev_b32 v60, 2, v1
    buffer_load_dword v32, v60, s[8:11], s49 offen
    s_mov_b32 s6, 0x10000000
    s_mov_b32 s7, 0x20000
    s_mov_b32 s10, 2048
    s_mov_b32 s11, 0x20000
    s_lshl_b32 s60, s61, 5
    s_add_u32 s60, s60, s62
    v_mov_b32 v8, 65536
    v_mov_b32 v9, 1
    s_load_dwordx2 s[16:17], s[0:1], 64
    s_mov_b32 s18, 0x700000
    s_mov_b32 s19, 0x20000
    v_mov_b32 v5, 0x3ff
    v_mul_u32_u24 v3, 28672, v6
    v_lshl_or_b32 v3, v7, 4, v3
    s_and_b32 s40, s62, 1
    s_lshl_b32 s40, s40, 10
    s_lshl_b32 s41, s46, 8
    s_add_u32 s40, s40, s41
    s_lshr_b32 s41, s60, 1
    s_sub_u32 s41, s41, 64
    s_mul_i32 s52, s41, 114688
    s_add_u32 s52, s52, s40
    v_and_b32 v60, 8, v7
    v_cmp_eq_u32 vcc, 0, v60
    v_mov_b32 v60, 0x0c0c0302
    v_mov_b32 v61, 0x0c0c0100
    v_cndmask_b32 v60, v60, v61, vcc
    v_and_b32 v61, 1, v7
    v_lshlrev_b32 v61, 4, v61
    v_alignbit_b32 v60, v60, v60, v61
    v_bfe_u32 v62, v7, 1, 2
    v_mov_b32 v63, 0x0c0c0c0c
    v_cmp_eq_u32 vcc, 0, v62
    s_nop 1
    v_cndmask_b32 v48, v63, v60, vcc
    v_cmp_eq_u32 vcc, 1, v62
    s_nop 1
    v_cndmask_b32 v49, v63, v60, vcc
    v_cmp_eq_u32 vcc, 2, v62
    s_nop 1
    v_cndmask_b32 v50, v63, v60, vcc
    v_cmp_eq_u32 vcc, 3, v62
    s_nop 1
    v_cndmask_b32 v51, v63, v60, vcc
    s_waitcnt lgkmcnt(0)
    s_barrier
    s_waitcnt vmcnt(5)
    s_add_u32 s51, s51, s47
    buffer_load_dwordx4 v[84:87], v2, s[12:15], s51 offen nt
    s_waitcnt vmcnt(5)
    s_add_u32 s51, s51, s47
    buffer_load_dwordx4 v[88:91], v2, s[12:15], s51 offen nt
    s_waitcnt vmcnt(5)
    s_add_u32 s51, s51, s47
    buffer_load_dwordx4 v[92:95], v2, s[12:15], s51 offen nt
    s_waitcnt vmcnt(5)
    s_add_u32 s51, s51, s47
    buffer_load_dwordx4 v[96:99], v2, s[12:15], s51 offen nt
    s_waitcnt vmcnt(5)
    s_add_u32 s51, s51, s47
    buffer_load_dwordx4 v[100:103], v2, s[12:15], s51 offen nt
    s_waitcnt vmcnt(4)
    s_add_u32 s51, s51, s47
    buffer_load_dwordx4 v[104:107], v2, s[12:15], s51 offen nt
    s_mov_b32 s44, 0
L_tg3:
    ds_read_b128 v[60:63], v8 offset:7312
    s_waitcnt lgkmcnt(0)
    v_readfirstlane_b32 s45, v62
    v_readfirstlane_b32 s38, v60
    v_readfirstlane_b32 s39, v61
    s_bitcmp1_b32 s45, 0
    s_cbranch_scc1 L_tg3_ok
    s_sleep 1
    s_add_u32 s44, s44, 1
    s_cmp_lt_u32 s44, 1600000
    s_cbranch_scc1 L_tg3
L_tg3_ok:
    s_and_b32 s30, s38, 0xfff
    s_bfe_u32 s31, s38, 0xc000c
    s_and_b32 s32, s39, 0xfff
    s_bfe_u32 s33, s39, 0xc000c
    v_and_b32 v62, 0xffff0000, v62
    v_lshlrev_b32 v34, 16, v32
    v_and_b32 v35, 0xffff0000, v32
    v_sub_f32 v34, v34, v62
    v_sub_f32 v35, v35, v62
    v_cvt_pk_bf16_f32 v36, v34, v35
    v_lshlrev_b32 v34, 16, v36
    v_and_b32 v35, 0xffff0000, v36
    v_mul_f32 v34, v34, v63
    v_mul_f32 v35, v35, v63
    v_cvt_pk_bf16_f32 v36, v34, v35
    s_lshl_b32 s40, s46, 8
    s_add_u32 s40, s40, 65536
    v_lshl_add_u32 v37, v1, 2, s40
    ds_write_b32 v37, v36
    v_lshl_add_u32 v37, v6, 6, s40
    ds_read_b128 v[16:19], v37 offset:0
    ds_read_b128 v[20:23], v37 offset:16
    ds_read_b128 v[24:27], v37 offset:32
    ds_read_b128 v[28:31], v37 offset:48
    s_lshl_b32 s40, s46, 9
    s_add_u32 s40, s40, 66560
    v_lshl_add_u32 v33, v7, 1, v6
    v_lshl_add_u32 v33, v33, 4, s40
    s_waitcnt lgkmcnt(0)
    v_perm_b32 v40, v16, v16, v48
    v_perm_b32 v41, v16, v16, v49
    v_perm_b32 v42, v16, v16, v50
    v_perm_b32 v43, v16, v16, v51
    s_nop 1
    v_mfma_f32_16x16x32_bf16 v[56:59], v[40:43], v[64:67], 0
    v_mfma_f32_16x16x32_bf16 v[52:55], v[40:43], v[68:71], 0
    v_perm_b32 v44, v17, v17, v48
    v_perm_b32 v45, v17, v17, v49
    v_perm_b32 v46, v17, v17, v50
    v_perm_b32 v47, v17, v17, v51
    s_nop 1
    v_mfma_f32_16x16x32_bf16 v[56:59], v[44:47], v[72:75], v[56:59]
    s_waitcnt vmcnt(4)
    s_add_u32 s51, s51, s47
    buffer_load_dwordx4 v[108:111], v2, s[12:15], s51 offen nt
    v_mfma_f32_16x16x32_bf16 v[52:55], v[44:47], v[76:79], v[52:55]
    v_perm_b32 v40, v18, v18, v48
    v_perm_b32 v41, v18, v18, v49
    v_perm_b32 v42, v18, v18, v50
    v_perm_b32 v43, v18, v18, v51
    s_nop 1
    v_mfma_f32_16x16x32_bf16 v[56:59], v[40:43], v[80:83], v[56:59]
    v_mfma_f32_16x16x32_bf16 v[52:55], v[40:43], v[84:87], v[52:55]
    s_waitcnt vmcnt(4)
    s_add_u32 s51, s51, s47
    buffer_load_dwordx4 v[112:115], v2, s[12:15], s51 offen nt
    v_perm_b32 v44, v19, v19, v48
    v_perm_b32 v45, v19, v19, v49
    v_perm_b32 v46, v19, v19, v50
    v_perm_b32 v47, v19, v19, v51
    s_nop 1
    v_mfma_f32_16x16x32_bf16 v[56:59], v[44:47], v[88:91], v[56:59]
    v_mfma_f32_16x16x32_bf16 v[52:55], v[44:47], v[92:95], v[52:55]
    s_waitcnt vmcnt(4)
    s_add_u32 s51, s51, s47
    buffer_load_dwordx4 v[116:119], v2, s[12:15], s51 offen nt
    v_perm_b32 v40, v20, v20, v48
    v_perm_b32 v41, v20, v20, v49
    v_perm_b32 v42, v20, v20, v50
    v_perm_b32 v43, v20, v20, v51
    s_nop 1
    v_mfma_f32_16x16x32_bf16 v[56:59], v[40:43], v[96:99], v[56:59]
    s_waitcnt vmcnt(4)
    s_add_u32 s51, s51, s47
    buffer_load_dwordx4 v[120:123], v2, s[12:15], s51 offen nt
    v_mfma_f32_16x16x32_bf16 v[52:55], v[40:43], v[100:103], v[52:55]
    s_waitcnt vmcnt(4)
    s_add_u32 s51, s51, s47
    buffer_load_dwordx4 v[124:127], v2, s[12:15], s51 offen nt
    v_perm_b32 v44, v21, v21, v48
    v_perm_b32 v45, v21, v21, v49
    v_perm_b32 v46, v21, v21, v50
    v_perm_b32 v47, v21, v21, v51
    s_nop 1
    v_mfma_f32_16x16x32_bf16 v[56:59], v[44:47], v[104:107], v[56:59]
    s_waitcnt vmcnt(4)
    s_add_u32 s51, s51, s47
    buffer_load_dwordx4 v[64:67], v2, s[12:15], s51 offen nt
    v_mfma_f32_16x16x32_bf16 v[52:55], v[44:47], v[108:111], v[52:55]
    s_waitcnt vmcnt(4)
    s_add_u32 s51, s51, s47
    buffer_load_dwordx4 v[68:71], v2, s[12:15], s51 offen nt
    v_perm_b32 v40, v22, v22, v48
    v_perm_b32 v41, v22, v22, v49
    v_perm_b32 v42, v22, v22, v50
    v_perm_b32 v43, v22, v22, v51
    s_nop 1
    v_mfma_f32_16x16x32_bf16 v[56:59], v[40:43], v[112:115], v[56:59]
    s_waitcnt vmcnt(4)
    s_add_u32 s51, s51, s47
    buffer_load_dwordx4 v[72:75], v2, s[12:15], s51 offen nt
    v_mfma_f32_16x16x32_bf16 v[52:55], v[40:43], v[116:119], v[52:55]
    s_waitcnt vmcnt(4)
    s_add_u32 s51, s51, s47
    buffer_load_dwordx4 v[76:79], v2, s[12:15], s51 offen nt
    v_perm_b32 v44, v23, v23, v48
    v_perm_b32 v45, v23, v23, v49
    v_perm_b32 v46, v23, v23, v50
    v_perm_b32 v47, v23, v23, v51
    s_nop 1
    v_mfma_f32_16x16x32_bf16 v[56:59], v[44:47], v[120:123], v[56:59]
    s_waitcnt vmcnt(4)
    s_add_u32 s51, s51, s47
    buffer_load_dwordx4 v[80:83], v2, s[12:15], s51 offen nt
    v_mfma_f32_16x16x32_bf16 v[52:55], v[44:47], v[124:127], v[52:55]
    s_waitcnt vmcnt(4)
    s_add_u32 s51, s51, s47
    buffer_load_dwordx4 v[84:87], v2, s[12:15], s51 offen nt
    v_perm_b32 v40, v24, v24, v48
    v_perm_b32 v41, v24, v24, v49
    v_perm_b32 v42, v24, v24, v50
    v_perm_b32 v43, v24, v24, v51
    s_nop 1
    v_mfma_f32_16x16x32_bf16 v[56:59], v[40:43], v[64:67], v[56:59]
    s_waitcnt vmcnt(4)
    s_add_u32 s51, s51, s47
    buffer_load_dwordx4 v[88:91], v2, s[12:15], s51 offen nt
    v_mfma_f32_16x16x32_bf16 v[52:55], v[40:43], v[68:71], v[52:55]
    s_waitcnt vmcnt(4)
    s_add_u32 s51, s51, s47
    buffer_load_dwordx4 v[92:95], v2, s[12:15], s51 offen nt
    v_perm_b32 v44, v25, v25, v48
    v_perm_b32 v45, v25, v25, v49
    v_perm_b32 v46, v25, v25, v50
    v_perm_b32 v47, v25, v25, v51
    s_nop 1
    v_mfma_f32_16x16x32_bf16 v[56:59], v[44:47], v[72:75], v[56:59]
    s_waitcnt vmcnt(4)
    s_add_u32 s51, s51, s47
    buffer_load_dwordx4 v[96:99], v2, s[12:15], s51 offen nt
    v_mfma_f32_16x16x32_bf16 v[52:55], v[44:47], v[76:79], v[52:55]
    s_waitcnt vmcnt(4)
    s_add_u32 s51, s51, s47
    buffer_load_dwordx4 v[100:103], v2, s[12:15], s51 offen nt
    v_perm_b32 v40, v26, v26, v48
    v_perm_b32 v41, v26, v26, v49
    v_perm_b32 v42, v26, v26, v50
    v_perm_b32 v43, v26, v26, v51
    s_nop 1
    v_mfma_f32_16x16x32_bf16 v[56:59], v[40:43], v[80:83], v[56:59]
    s_waitcnt vmcnt(4)
    s_add_u32 s51, s51, s47
    buffer_load_dwordx4 v[104:107], v2, s[12:15], s51 offen nt
    v_mfma_f32_16x16x32_bf16 v[52:55], v[40:43], v[84:87], v[52:55]
    s_waitcnt vmcnt(4)
    s_add_u32 s51, s51, s47
    buffer_load_dwordx4 v[108:111], v2, s[12:15], s51 offen nt
    v_perm_b32 v44, v27, v27, v48
    v_perm_b32 v45, v27, v27, v49
    v_perm_b32 v46, v27, v27, v50
    v_perm_b32 v47, v27, v27, v51
    s_nop 1
    v_mfma_f32_16x16x32_bf16 v[56:59], v[44:47], v[88:91], v[56:59]
    s_waitcnt vmcnt(4)
    s_add_u32 s51, s51, s47
    buffer_load_dwordx4 v[112:115], v2, s[12:15], s51 offen nt
    v_mfma_f32_16x16x32_bf16 v[52:55], v[44:47], v[92:95], v[52:55]
    s_waitcnt vmcnt(4)
    s_add_u32 s51, s51, s47
    buffer_load_dwordx4 v[116:119], v2, s[12:15], s51 offen nt
    v_perm_b32 v40, v28, v28, v48
    v_perm_b32 v41, v28, v28, v49
    v_perm_b32 v42, v28, v28, v50
    v_perm_b32 v43, v28, v28, v51
    s_nop 1
    v_mfma_f32_16x16x32_bf16 v[56:59], v[40:43], v[96:99], v[56:59]
    s_waitcnt vmcnt(4)
    s_add_u32 s51, s51, s47
    buffer_load_dwordx4 v[120:123], v2, s[12:15], s51 offen nt
    v_mfma_f32_16x16x32_bf16 v[52:55], v[40:43], v[100:103], v[52:55]
    s_waitcnt vmcnt(4)
    s_add_u32 s51, s51, s47
    buffer_load_dwordx4 v[124:127], v2, s[12:15], s51 offen nt
    v_perm_b32 v44, v29, v29, v48
    v_perm_b32 v45, v29, v29, v49
    v_perm_b32 v46, v29, v29, v50
    v_perm_b32 v47, v29, v29, v51
    s_nop 1
    v_mfma_f32_16x16x32_bf16 v[56:59], v[44:47], v[104:107], v[56:59]
    s_waitcnt vmcnt(4)
    buffer_load_dwordx4 v[64:67], v3, s[16:19], s52 offen offset:0 nt
    v_mfma_f32_16x16x32_bf16 v[52:55], v[44:47], v[108:111], v[52:55]
    s_waitcnt vmcnt(4)
    buffer_load_dwordx4 v[68:71], v3, s[16:19], s52 offen offset:2048 nt
    v_perm_b32 v40, v30, v30, v48
    v_perm_b32 v41, v30, v30, v49
    v_perm_b32 v42, v30, v30, v50
    v_perm_b32 v43, v30, v30, v51
    s_nop 1
    v_mfma_f32_16x16x32_bf16 v[56:59], v[40:43], v[112:115], v[56:59]
    s_waitcnt vmcnt(4)
    s_add_u32 s52, s52, 4096
    buffer_load_dwordx4 v[72:75], v3, s[16:19], s52 offen offset:0 nt
    v_mfma_f32_16x16x32_bf16 v[52:55], v[40:43], v[116:119], v[52:55]
    s_waitcnt vmcnt(4)
    buffer_load_dwordx4 v[76:79], v3, s[16:19], s52 offen offset:2048 nt
    v_perm_b32 v44, v31, v31, v48
    v_perm_b32 v45, v31, v31, v49
    v_perm_b32 v46, v31, v31, v50
    v_perm_b32 v47, v31, v31, v51
    s_nop 1
    v_mfma_f32_16x16x32_bf16 v[56:59], v[44:47], v[120:123], v[56:59]
    s_waitcnt vmcnt(4)
    s_add_u32 s52, s52, 4096
    buffer_load_dwordx4 v[80:83], v3, s[16:19], s52 offen offset:0 nt
    v_mfma_f32_16x16x32_bf16 v[52:55], v[44:47], v[124:127], v[52:55]
    s_nop 7
    v_permlane32_swap_b32 v52, v53
    v_permlane32_swap_b32 v54, v55
    v_add_f32 v56, v56, v53
    v_add_f32 v58, v58, v55
    v_permlane32_swap_b32 v53, v52
    v_permlane32_swap_b32 v55, v54
    v_add_f32 v57, v57, v52
    v_add_f32 v59, v59, v54
    s_mov_b32 exec_hi, 0
    ds_write_b128 v33, v[56:59]
    s_mov_b64 exec, 1
    ds_add_u32 v8, v9 offset:7296
    s_mov_b64 exec, -1
    s_waitcnt vmcnt(4)
    buffer_load_dwordx4 v[84:87], v3, s[16:19], s52 offen offset:2048 nt
    s_waitcnt vmcnt(4)
    s_add_u32 s52, s52, 4096
    buffer_load_dwordx4 v[88:91], v3, s[16:19], s52 offen offset:0 nt
    s_mov_b64 exec, 1
    ds_add_u32 v8, v9 offset:7340
    s_mov_b64 exec, -1
    s_waitcnt vmcnt(4)
    buffer_load_dwordx4 v[92:95], v3, s[16:19], s52 offen offset:2048 nt
    s_waitcnt vmcnt(4)
    s_add_u32 s52, s52, 4096
    buffer_load_dwordx4 v[96:99], v3, s[16:19], s52 offen offset:0 nt
    s_mov_b64 exec, 1
    ds_add_u32 v8, v9 offset:7340
    s_mov_b64 exec, -1
    s_waitcnt vmcnt(4)
    buffer_load_dwordx4 v[100:103], v3, s[16:19], s52 offen offset:2048 nt
    s_waitcnt vmcnt(4)
    s_add_u32 s52, s52, 4096
    buffer_load_dwordx4 v[104:107], v3, s[16:19], s52 offen offset:0 nt
    s_mov_b64 exec, 1
    ds_add_u32 v8, v9 offset:7340
    s_mov_b64 exec, -1
    s_waitcnt vmcnt(4)
    buffer_load_dwordx4 v[108:111], v3, s[16:19], s52 offen offset:2048 nt
    s_waitcnt vmcnt(4)
    s_add_u32 s52, s52, 4096
    buffer_load_dwordx4 v[112:115], v3, s[16:19], s52 offen offset:0 nt
    s_waitcnt vmcnt(4)
    buffer_load_dwordx4 v[116:119], v3, s[16:19], s52 offen offset:2048 nt
    s_branch L_Sfin
L_SM:
    v_lshlrev_b32 v60, 2, v1
    s_lshl_b32 s42, s57, 2
    s_add_u32 s42, s42, s46
    s_sub_u32 s41, s61, 4
    s_mul_i32 s50, s41, 7
    s_add_u32 s50, s50, 6
    s_lshl_b32 s50, s50, 8
    s_mul_i32 s40, s42, 458752
    s_add_u32 s50, s50, s40
    s_lshl_b32 s42, s42, 7
    s_sub_u32 s42, s42, 128
    s_sub_u32 s42, s42, s49
    v_mov_b32 v62, s42
    v_cmp_gt_u32 vcc, 32, v1
    s_nop 1
    v_cndmask_b32 v61, v62, 0, vcc
    v_add_u32 v60, v60, v61
    v_add_u32 v60, s49, v60
    buffer_load_dword v32, v60, s[8:11], 0 offen
    v_mul_u32_u24 v10, 114688, v6
    v_lshl_add_u32 v10, v7, 4, v10
    s_cmp_eq_u32 s56, 1
    s_cselect_b32 s20, s26, s24
    s_cselect_b32 s21, s27, s25
    s_mov_b32 s22, 0x700000
    s_mov_b32 s23, 0x20000
    s_add_u32 s51, s51, s47
    buffer_load_dwordx4 v[84:87], v2, s[12:15], s51 offen nt
    s_add_u32 s51, s51, s47
    buffer_load_dwordx4 v[88:91], v2, s[12:15], s51 offen nt
    s_add_u32 s51, s51, s47
    buffer_load_dwordx4 v[92:95], v2, s[12:15], s51 offen nt
    s_mov_b32 s6, 0x10000000
    s_mov_b32 s7, 0x20000
    s_mov_b32 s10, 2048
    s_mov_b32 s11, 0x20000
    s_lshl_b32 s60, s61, 5
    s_add_u32 s60, s60, s62
    v_mov_b32 v8, 65536
    v_mov_b32 v9, 1
    s_load_dwordx2 s[16:17], s[0:1], 64
    s_mov_b32 s18, 0x700000
    s_mov_b32 s19, 0x20000
    v_mov_b32 v5, 0x3ff
    v_mul_u32_u24 v3, 28672, v6
    v_lshl_or_b32 v3, v7, 4, v3
    s_and_b32 s40, s62, 1
    s_lshl_b32 s40, s40, 10
    s_lshl_b32 s41, s46, 8
    s_add_u32 s40, s40, s41
    s_lshr_b32 s41, s60, 1
    s_sub_u32 s41, s41, 64
    s_mul_i32 s52, s41, 114688
    s_add_u32 s52, s52, s40
    v_and_b32 v60, 8, v7
    v_cmp_eq_u32 vcc, 0, v60
    v_mov_b32 v60, 0x0c0c0302
    v_mov_b32 v61, 0x0c0c0100
    v_cndmask_b32 v60, v60, v61, vcc
    v_and_b32 v61, 1, v7
    v_lshlrev_b32 v61, 4, v61
    v_alignbit_b32 v60, v60, v60, v61
    v_bfe_u32 v62, v7, 1, 2
    v_mov_b32 v63, 0x0c0c0c0c
    v_cmp_eq_u32 vcc, 0, v62
    s_nop 1
    v_cndmask_b32 v48, v63, v60, vcc
    v_cmp_eq_u32 vcc, 1, v62
    s_nop 1
    v_cndmask_b32 v49, v63, v60, vcc
    v_cmp_eq_u32 vcc, 2, v62
    s_nop 1
    v_cndmask_b32 v50, v63, v60, vcc
    v_cmp_eq_u32 vcc, 3, v62
    s_nop 1
    v_cndmask_b32 v51, v63, v60, vcc
    s_waitcnt lgkmcnt(0)
    s_barrier
    s_waitcnt vmcnt(8)
    s_add_u32 s51, s51, s47
    buffer_load_dwordx4 v[96:99], v2, s[12:15], s51 offen nt
    s_waitcnt vmcnt(8)
    s_add_u32 s51, s51, s47
    buffer_load_dwordx4 v[100:103], v2, s[12:15], s51 offen nt
    s_waitcnt vmcnt(8)
    s_add_u32 s51, s51, s47
    buffer_load_dwordx4 v[104:107], v2, s[12:15], s51 offen nt
    s_waitcnt vmcnt(8)
    s_add_u32 s51, s51, s47
    buffer_load_dwordx4 v[108:111], v2, s[12:15], s51 offen nt
    s_waitcnt vmcnt(8)
    s_add_u32 s51, s51, s47
    buffer_load_dwordx4 v[112:115], v2, s[12:15], s51 offen nt
    s_waitcnt vmcnt(7)
    s_add_u32 s51, s51, s47
    buffer_load_dwordx4 v[116:119], v2, s[12:15], s51 offen nt
    s_mov_b32 s44, 0
L_tg4:
    ds_read_b128 v[60:63], v8 offset:7312
    s_waitcnt lgkmcnt(0)
    v_readfirstlane_b32 s45, v62
    v_readfirstlane_b32 s38, v60
    v_readfirstlane_b32 s39, v61
    s_bitcmp1_b32 s45, 0
    s_cbranch_scc1 L_tg4_ok
    s_sleep 1
    s_add_u32 s44, s44, 1
    s_cmp_lt_u32 s44, 1600000
    s_cbranch_scc1 L_tg4
L_tg4_ok:
    s_and_b32 s30, s38, 0xfff
    s_bfe_u32 s31, s38, 0xc000c
    s_and_b32 s32, s39, 0xfff
    s_bfe_u32 s33, s39, 0xc000c
    v_and_b32 v62, 0xffff0000, v62
    v_lshlrev_b32 v34, 16, v32
    v_and_b32 v35, 0xffff0000, v32
    v_sub_f32 v34, v34, v62
    v_sub_f32 v35, v35, v62
    v_cvt_pk_bf16_f32 v36, v34, v35
    v_lshlrev_b32 v34, 16, v36
    v_and_b32 v35, 0xffff0000, v36
    v_mul_f32 v34, v34, v63
    v_mul_f32 v35, v35, v63
    v_cvt_pk_bf16_f32 v36, v34, v35
    s_lshl_b32 s40, s46, 8
    s_add_u32 s40, s40, 65536
    v_lshl_add_u32 v37, v1, 2, s40
    ds_write_b32 v37, v36
    v_lshl_add_u32 v37, v6, 5, s40
    v_lshl_add_u32 v38, v6, 5, s40
    ds_read_b128 v[16:19], v38 offset:0
    ds_read_b128 v[20:23], v38 offset:16
    ds_read_b128 v[24:27], v37 offset:128
    ds_read_b128 v[28:31], v37 offset:144
    s_lshl_b32 s40, s46, 9
    s_add_u32 s40, s40, 66560
    v_lshl_add_u32 v33, v7, 1, v6
    v_lshl_add_u32 v33, v33, 4, s40
    s_waitcnt lgkmcnt(0)
    v_perm_b32 v40, v16, v16, v48
    v_perm_b32 v41, v16, v16, v49
    v_perm_b32 v42, v16, v16, v50
    v_perm_b32 v43, v16, v16, v51
    s_nop 1
    v_mfma_f32_16x16x32_bf16 v[56:59], v[40:43], v[64:67], 0
    v_mfma_f32_16x16x32_bf16 v[52:55], v[40:43], v[68:71], 0
    v_perm_b32 v44, v17, v17, v48
    v_perm_b32 v45, v17, v17, v49
    v_perm_b32 v46, v17, v17, v50
    v_perm_b32 v47, v17, v17, v51
    s_nop 1
    v_mfma_f32_16x16x32_bf16 v[56:59], v[44:47], v[72:75], v[56:59]
    s_waitcnt vmcnt(7)
    s_add_u32 s51, s51, s47
    buffer_load_dwordx4 v[120:123], v2, s[12:15], s51 offen nt
    v_mfma_f32_16x16x32_bf16 v[52:55], v[44:47], v[76:79], v[52:55]
    v_perm_b32 v40, v18, v18, v48
    v_perm_b32 v41, v18, v18, v49
    v_perm_b32 v42, v18, v18, v50
    v_perm_b32 v43, v18, v18, v51
    s_nop 1
    v_mfma_f32_16x16x32_bf16 v[56:59], v[40:43], v[80:83], v[56:59]
    v_mfma_f32_16x16x32_bf16 v[52:55], v[40:43], v[84:87], v[52:55]
    s_waitcnt vmcnt(7)
    s_add_u32 s51, s51, s47
    buffer_load_dwordx4 v[124:127], v2, s[12:15], s51 offen nt
    v_perm_b32 v44, v19, v19, v48
    v_perm_b32 v45, v19, v19, v49
    v_perm_b32 v46, v19, v19, v50
    v_perm_b32 v47, v19, v19, v51
    s_nop 1
    v_mfma_f32_16x16x32_bf16 v[56:59], v[44:47], v[88:91], v[56:59]
    v_mfma_f32_16x16x32_bf16 v[52:55], v[44:47], v[92:95], v[52:55]
    s_waitcnt vmcnt(4)
    buffer_load_dwordx4 v[64:67], v10, s[20:23], s50 offen nt
    v_perm_b32 v40, v20, v20, v48
    v_perm_b32 v41, v20, v20, v49
    v_perm_b32 v42, v20, v20, v50
    v_perm_b32 v43, v20, v20, v51
    s_nop 1
    v_mfma_f32_16x16x32_bf16 v[56:59], v[40:43], v[96:99], v[56:59]
    v_mfma_f32_16x16x32_bf16 v[52:55], v[40:43], v[100:103], v[52:55]
    v_perm_b32 v44, v21, v21, v48
    v_perm_b32 v45, v21, v21, v49
    v_perm_b32 v46, v21, v21, v50
    v_perm_b32 v47, v21, v21, v51
    s_nop 1
    v_mfma_f32_16x16x32_bf16 v[56:59], v[44:47], v[104:107], v[56:59]
    s_waitcnt vmcnt(4)
    s_add_u32 s50, s50, 7168
    buffer_load_dwordx4 v[68:71], v10, s[20:23], s50 offen nt
    v_mfma_f32_16x16x32_bf16 v[52:55], v[44:47], v[108:111], v[52:55]
    v_perm_b32 v40, v22, v22, v48
    v_perm_b32 v41, v22, v22, v49
    v_perm_b32 v42, v22, v22, v50
    v_perm_b32 v43, v22, v22, v51
    s_nop 1
    v_mfma_f32_16x16x32_bf16 v[56:59], v[40:43], v[112:115], v[56:59]
    s_waitcnt vmcnt(4)
    s_add_u32 s50, s50, 7168
    buffer_load_dwordx4 v[72:75], v10, s[20:23], s50 offen nt
    v_mfma_f32_16x16x32_bf16 v[52:55], v[40:43], v[116:119], v[52:55]
    s_waitcnt vmcnt(4)
    s_add_u32 s50, s50, 7168
    buffer_load_dwordx4 v[76:79], v10, s[20:23], s50 offen nt
    v_perm_b32 v44, v23, v23, v48
    v_perm_b32 v45, v23, v23, v49
    v_perm_b32 v46, v23, v23, v50
    v_perm_b32 v47, v23, v23, v51
    s_nop 1
    v_mfma_f32_16x16x32_bf16 v[56:59], v[44:47], v[120:123], v[56:59]
    s_waitcnt vmcnt(4)
    s_add_u32 s50, s50, 7168
    buffer_load_dwordx4 v[80:83], v10, s[20:23], s50 offen nt
    v_mfma_f32_16x16x32_bf16 v[52:55], v[44:47], v[124:127], v[52:55]
    s_nop 7
    v_permlane32_swap_b32 v52, v53
    v_permlane32_swap_b32 v54, v55
    v_add_f32 v56, v56, v53
    v_add_f32 v58, v58, v55
    v_permlane32_swap_b32 v53, v52
    v_permlane32_swap_b32 v55, v54
    v_add_f32 v57, v57, v52
    v_add_f32 v59, v59, v54
    s_mov_b32 exec_hi, 0
    ds_write_b128 v33, v[56:59] offset:2048
    s_mov_b64 exec, 1
    ds_add_u32 v8, v9 offset:7300
    s_mov_b64 exec, -1
    s_waitcnt vmcnt(4)
    s_add_u32 s50, s50, 7168
    buffer_load_dwordx4 v[84:87], v10, s[20:23], s50 offen nt
    v_perm_b32 v40, v24, v24, v48
    v_perm_b32 v41, v24, v24, v49
    v_perm_b32 v42, v24, v24, v50
    v_perm_b32 v43, v24, v24, v51
    s_nop 1
    v_mfma_f32_16x16x32_bf16 v[56:59], v[40:43], v[64:67], 0
    s_waitcnt vmcnt(4)
    s_add_u32 s50, s50, 7168
    buffer_load_dwordx4 v[88:91], v10, s[20:23], s50 offen nt
    v_mfma_f32_16x16x32_bf16 v[52:55], v[40:43], v[68:71], 0
    s_waitcnt vmcnt(4)
    s_add_u32 s50, s50, 7168
    buffer_load_dwordx4 v[92:95], v10, s[20:23], s50 offen nt
    v_perm_b32 v44, v25, v25, v48
    v_perm_b32 v45, v25, v25, v49
    v_perm_b32 v46, v25, v25, v50
    v_perm_b32 v47, v25, v25, v51
    s_nop 1
    v_mfma_f32_16x16x32_bf16 v[56:59], v[44:47], v[72:75], v[56:59]
    s_waitcnt vmcnt(4)
    s_add_u32 s50, s50, 7168
    buffer_load_dwordx4 v[96:99], v10, s[20:23], s50 offen nt
    v_mfma_f32_16x16x32_bf16 v[52:55], v[44:47], v[76:79], v[52:55]
    s_waitcnt vmcnt(4)
    s_add_u32 s50, s50, 7168
    buffer_load_dwordx4 v[100:103], v10, s[20:23], s50 offen nt
    v_perm_b32 v40, v26, v26, v48
    v_perm_b32 v41, v26, v26, v49
    v_perm_b32 v42, v26, v26, v50
    v_perm_b32 v43, v26, v26, v51
    s_nop 1
    v_mfma_f32_16x16x32_bf16 v[56:59], v[40:43], v[80:83], v[56:59]
    s_waitcnt vmcnt(4)
    s_add_u32 s50, s50, 7168
    buffer_load_dwordx4 v[104:107], v10, s[20:23], s50 offen nt
    v_mfma_f32_16x16x32_bf16 v[52:55], v[40:43], v[84:87], v[52:55]
    s_waitcnt vmcnt(4)
    s_add_u32 s50, s50, 7168
    buffer_load_dwordx4 v[108:111], v10, s[20:23], s50 offen nt
    v_perm_b32 v44, v27, v27, v48
    v_perm_b32 v45, v27, v27, v49
    v_perm_b32 v46, v27, v27, v50
    v_perm_b32 v47, v27, v27, v51
    s_nop 1
    v_mfma_f32_16x16x32_bf16 v[56:59], v[44:47], v[88:91], v[56:59]
    s_waitcnt vmcnt(4)
    s_add_u32 s50, s50, 7168
    buffer_load_dwordx4 v[112:115], v10, s[20:23], s50 offen nt
    v_mfma_f32_16x16x32_bf16 v[52:55], v[44:47], v[92:95], v[52:55]
    s_waitcnt vmcnt(4)
    s_add_u32 s50, s50, 7168
    buffer_load_dwordx4 v[116:119], v10, s[20:23], s50 offen nt
    v_perm_b32 v40, v28, v28, v48
    v_perm_b32 v41, v28, v28, v49
    v_perm_b32 v42, v28, v28, v50
    v_perm_b32 v43, v28, v28, v51
    s_nop 1
    v_mfma_f32_16x16x32_bf16 v[56:59], v[40:43], v[96:99], v[56:59]
    s_waitcnt vmcnt(4)
    s_add_u32 s50, s50, 7168
    buffer_load_dwordx4 v[120:123], v10, s[20:23], s50 offen nt
    v_mfma_f32_16x16x32_bf16 v[52:55], v[40:43], v[100:103], v[52:55]
    s_waitcnt vmcnt(4)
    s_add_u32 s50, s50, 7168
    buffer_load_dwordx4 v[124:127], v10, s[20:23], s50 offen nt
    v_perm_b32 v44, v29, v29, v48
    v_perm_b32 v45, v29, v29, v49
    v_perm_b32 v46, v29, v29, v50
    v_perm_b32 v47, v29, v29, v51
    s_nop 1
    v_mfma_f32_16x16x32_bf16 v[56:59], v[44:47], v[104:107], v[56:59]
    s_waitcnt vmcnt(4)
    buffer_load_dwordx4 v[64:67], v3, s[16:19], s52 offen offset:0 nt
    v_mfma_f32_16x16x32_bf16 v[52:55], v[44:47], v[108:111], v[52:55]
    s_waitcnt vmcnt(4)
    buffer_load_dwordx4 v[68:71], v3, s[16:19], s52 offen offset:2048 nt
    v_perm_b32 v40, v30, v30, v48
    v_perm_b32 v41, v30, v30, v49
    v_perm_b32 v42, v30, v30, v50
    v_perm_b32 v43, v30, v30, v51
    s_nop 1
    v_mfma_f32_16x16x32_bf16 v[56:59], v[40:43], v[112:115], v[56:59]
    s_waitcnt vmcnt(4)
    s_add_u32 s52, s52, 4096
    buffer_load_dwordx4 v[72:75], v3, s[16:19], s52 offen offset:0 nt
    v_mfma_f32_16x16x32_bf16 v[52:55], v[40:43], v[116:119], v[52:55]
    s_waitcnt vmcnt(4)
    buffer_load_dwordx4 v[76:79], v3, s[16:19], s52 offen offset:2048 nt
    v_perm_b32 v44, v31, v31, v48
    v_perm_b32 v45, v31, v31, v49
    v_perm_b32 v46, v31, v31, v50
    v_perm_b32 v47, v31, v31, v51
    s_nop 1
    v_mfma_f32_16x16x32_bf16 v[56:59], v[44:47], v[120:123], v[56:59]
    s_waitcnt vmcnt(4)
    s_add_u32 s52, s52, 4096
    buffer_load_dwordx4 v[80:83], v3, s[16:19], s52 offen offset:0 nt
    v_mfma_f32_16x16x32_bf16 v[52:55], v[44:47], v[124:127], v[52:55]
    s_nop 7
    v_permlane32_swap_b32 v52, v53
    v_permlane32_swap_b32 v54, v55
    v_add_f32 v56, v56, v53
    v_add_f32 v58, v58, v55
    v_permlane32_swap_b32 v53, v52
    v_permlane32_swap_b32 v55, v54
    v_add_f32 v57, v57, v52
    v_add_f32 v59, v59, v54
    s_mov_b32 exec_hi, 0
    ds_write_b128 v33, v[56:59]
    s_mov_b64 exec, 1
    ds_add_u32 v8, v9 offset:7296
    s_mov_b64 exec, -1
    s_waitcnt vmcnt(4)
    buffer_load_dwordx4 v[84:87], v3, s[16:19], s52 offen offset:2048 nt
    s_waitcnt vmcnt(4)
    s_add_u32 s52, s52, 4096
    buffer_load_dwordx4 v[88:91], v3, s[16:19], s52 offen offset:0 nt
    s_waitcnt vmcnt(4)
    buffer_load_dwordx4 v[92:95], v3, s[16:19], s52 offen offset:2048 nt
    s_waitcnt vmcnt(4)
    s_add_u32 s52, s52, 4096
    buffer_load_dwordx4 v[96:99], v3, s[16:19], s52 offen offset:0 nt
    s_waitcnt vmcnt(4)
    buffer_load_dwordx4 v[100:103], v3, s[16:19], s52 offen offset:2048 nt
    s_mov_b64 exec, 1
    ds_add_u32 v8, v9 offset:7340
    s_mov_b64 exec, -1
    s_waitcnt vmcnt(4)
    s_add_u32 s52, s52, 4096
    buffer_load_dwordx4 v[104:107], v3, s[16:19], s52 offen offset:0 nt
    s_waitcnt vmcnt(4)
    buffer_load_dwordx4 v[108:111], v3, s[16:19], s52 offen offset:2048 nt
    s_mov_b64 exec, 1
    ds_add_u32 v8, v9 offset:7340
    s_mov_b64 exec, -1
    s_waitcnt vmcnt(4)
    s_add_u32 s52, s52, 4096
    buffer_load_dwordx4 v[112:115], v3, s[16:19], s52 offen offset:0 nt
    s_waitcnt vmcnt(4)
    buffer_load_dwordx4 v[116:119], v3, s[16:19], s52 offen offset:2048 nt
    s_mov_b64 exec, 1
    ds_add_u32 v8, v9 offset:7340
    s_mov_b64 exec, -1
L_Sfin:
    v_and_b32 v11, 3, v7
    v_lshl_add_u32 v11, v11, 1, v6
    v_lshlrev_b32 v11, 4, v11
    v_lshrrev_b32 v12, 2, v7
    v_lshl_or_b32 v11, v12, 14, v11
    s_and_b32 s50, s60, 1
    s_lshl_b32 s50, s50, 2
    s_add_u32 s50, s50, s46
    s_lshl_b32 s50, s50, 16
    s_lshr_b32 s41, s60, 1
    s_lshl_b32 s41, s41, 7
    s_add_u32 s50, s50, s41
    s_add_u32 s50, s50, 1572864
    v_lshlrev_b32 v12, 5, v6
    v_add_u32 v12, 72704, v12
    s_mov_b32 s44, 0
L_lw5:
    ds_read_b32 v13, v8 offset:7332
    ds_read_b128 v[16:19], v12
    ds_read_b128 v[20:23], v12 offset:16
    s_waitcnt lgkmcnt(0)
    v_readfirstlane_b32 s45, v13
    s_nop 0
    s_cmp_ge_u32 s45, 2
    s_cbranch_scc1 L_lw5_ok
    s_add_u32 s44, s44, 1
    s_cmp_lt_u32 s44, 1600000
    s_cbranch_scc1 L_lw5
L_lw5_ok:
    v_perm_b32 v40, v16, v16, v48
    v_perm_b32 v41, v16, v16, v49
    v_perm_b32 v42, v16, v16, v50
    v_perm_b32 v43, v16, v16, v51
    s_nop 1
    v_mfma_f32_16x16x32_bf16 v[56:59], v[40:43], v[64:67], 0
    v_perm_b32 v44, v17, v17, v48
    v_perm_b32 v45, v17, v17, v49
    v_perm_b32 v46, v17, v17, v50
    v_perm_b32 v47, v17, v17, v51
    v_mfma_f32_16x16x32_bf16 v[52:55], v[40:43], v[68:71], 0
    s_nop 0
    v_mfma_f32_16x16x32_bf16 v[56:59], v[44:47], v[72:75], v[56:59]
    v_perm_b32 v40, v18, v18, v48
    v_perm_b32 v41, v18, v18, v49
    v_perm_b32 v42, v18, v18, v50
    v_perm_b32 v43, v18, v18, v51
    v_mfma_f32_16x16x32_bf16 v[52:55], v[44:47], v[76:79], v[52:55]
    s_nop 0
    v_mfma_f32_16x16x32_bf16 v[56:59], v[40:43], v[80:83], v[56:59]
    v_perm_b32 v44, v19, v19, v48
    v_perm_b32 v45, v19, v19, v49
    v_perm_b32 v46, v19, v19, v50
    v_perm_b32 v47, v19, v19, v51
    v_mfma_f32_16x16x32_bf16 v[52:55], v[40:43], v[84:87], v[52:55]
    s_waitcnt vmcnt(7)
    v_mfma_f32_16x16x32_bf16 v[56:59], v[44:47], v[88:91], v[56:59]
    v_perm_b32 v40, v20, v20, v48
    v_perm_b32 v41, v20, v20, v49
    v_perm_b32 v42, v20, v20, v50
    v_perm_b32 v43, v20, v20, v51
    s_waitcnt vmcnt(6)
    v_mfma_f32_16x16x32_bf16 v[52:55], v[44:47], v[92:95], v[52:55]
    s_waitcnt vmcnt(5)
    v_mfma_f32_16x16x32_bf16 v[56:59], v[40:43], v[96:99], v[56:59]
    v_perm_b32 v44, v21, v21, v48
    v_perm_b32 v45, v21, v21, v49
    v_perm_b32 v46, v21, v21, v50
    v_perm_b32 v47, v21, v21, v51
    s_waitcnt vmcnt(4)
    v_mfma_f32_16x16x32_bf16 v[52:55], v[40:43], v[100:103], v[52:55]
    s_waitcnt vmcnt(3)
    v_mfma_f32_16x16x32_bf16 v[56:59], v[44:47], v[104:107], v[56:59]
    v_perm_b32 v40, v22, v22, v48
    v_perm_b32 v41, v22, v22, v49
    v_perm_b32 v42, v22, v22, v50
    v_perm_b32 v43, v22, v22, v51
    s_waitcnt vmcnt(2)
    v_mfma_f32_16x16x32_bf16 v[52:55], v[44:47], v[108:111], v[52:55]
    s_waitcnt vmcnt(1)
    v_mfma_f32_16x16x32_bf16 v[56:59], v[40:43], v[112:115], v[56:59]
    s_waitcnt vmcnt(0)
    v_mfma_f32_16x16x32_bf16 v[52:55], v[40:43], v[116:119], v[52:55]
    s_nop 7
    v_permlane32_swap_b32 v52, v53
    v_permlane32_swap_b32 v54, v55
    v_add_f32 v56, v56, v53
    v_add_f32 v58, v58, v55
    v_permlane32_swap_b32 v53, v52
    v_permlane32_swap_b32 v55, v54
    v_add_f32 v57, v57, v52
    v_add_f32 v59, v59, v54
    v_add_u32 v56, 512, v56
    v_add_u32 v57, 512, v57
    v_add_u32 v58, 512, v58
    v_add_u32 v59, 512, v59
    v_bfi_b32 v56, v5, s30, v56
    v_bfi_b32 v57, v5, s31, v57
    v_bfi_b32 v58, v5, s32, v58
    v_bfi_b32 v59, v5, s33, v59
    s_mov_b32 exec_hi, 0
    buffer_store_dwordx4 v[56:59], v11, s[4:7], s50 offen sc1
    s_barrier
    s_branch L_fin
L_C0:
    s_mov_b32 s6, 0x10000000
    s_mov_b32 s7, 0x20000
    s_mov_b32 s10, 2048
    s_mov_b32 s11, 0x20000
    s_lshl_b32 s60, s61, 5
    s_add_u32 s60, s60, s62
    v_mov_b32 v8, 65536
    v_mov_b32 v9, 1
    s_barrier
    s_waitcnt vmcnt(1)
    v_lshlrev_b32 v28, 16, v16
    v_and_b32 v29, 0xffff0000, v16
    v_lshlrev_b32 v30, 16, v17
    v_and_b32 v31, 0xffff0000, v17
    v_lshlrev_b32 v32, 16, v18
    v_and_b32 v33, 0xffff0000, v18
    v_lshlrev_b32 v34, 16, v19
    v_and_b32 v35, 0xffff0000, v19
    v_lshlrev_b32 v36, 16, v20
    v_and_b32 v37, 0xffff0000, v20
    v_lshlrev_b32 v38, 16, v21
    v_and_b32 v39, 0xffff0000, v21
    v_lshlrev_b32 v40, 16, v22
    v_and_b32 v41, 0xffff0000, v22
    v_lshlrev_b32 v42, 16, v23
    v_and_b32 v43, 0xffff0000, v23
    v_pk_add_f32 v[16:17], v[28:29], v[30:31]
    v_pk_add_f32 v[18:19], v[32:33], v[34:35]
    v_pk_add_f32 v[20:21], v[36:37], v[38:39]
    v_pk_add_f32 v[22:23], v[40:41], v[42:43]
    v_pk_add_f32 v[16:17], v[16:17], v[18:19]
    v_pk_add_f32 v[20:21], v[20:21], v[22:23]
    v_pk_add_f32 v[16:17], v[16:17], v[20:21]
    v_add_f32 v44, v16, v17
    s_nop 1
    v_add_f32_dpp v44, v44, v44 row_ror:8 row_mask:0xf bank_mask:0xf
    s_nop 1
    v_add_f32_dpp v44, v44, v44 row_ror:4 row_mask:0xf bank_mask:0xf
    s_nop 1
    v_add_f32_dpp v44, v44, v44 row_ror:2 row_mask:0xf bank_mask:0xf
    s_nop 1
    v_add_f32_dpp v44, v44, v44 row_ror:1 row_mask:0xf bank_mask:0xf
    v_mov_b32 v45, v44
    s_nop 1
    v_permlane16_swap_b32 v44, v45
    v_add_f32 v44, v44, v45
    v_mov_b32 v45, v44
    s_nop 1
    v_permlane32_swap_b32 v44, v45
    v_add_f32 v44, v44, v45
    v_mul_f32 v44, 0x3a800000, v44
    v_mov_b32 v18, v44
    v_mov_b32 v19, v44
    v_pk_add_f32 v[28:29], v[28:29], v[18:19] neg_lo:[0,1] neg_hi:[0,1]
    v_pk_add_f32 v[30:31], v[30:31], v[18:19] neg_lo:[0,1] neg_hi:[0,1]
    v_pk_add_f32 v[32:33], v[32:33], v[18:19] neg_lo:[0,1] neg_hi:[0,1]
    v_pk_add_f32 v[34:35], v[34:35], v[18:19] neg_lo:[0,1] neg_hi:[0,1]
    v_pk_add_f32 v[36:37], v[36:37], v[18:19] neg_lo:[0,1] neg_hi:[0,1]
    v_pk_add_f32 v[38:39], v[38:39], v[18:19] neg_lo:[0,1] neg_hi:[0,1]
    v_pk_add_f32 v[40:41], v[40:41], v[18:19] neg_lo:[0,1] neg_hi:[0,1]
    v_pk_add_f32 v[42:43], v[42:43], v[18:19] neg_lo:[0,1] neg_hi:[0,1]
    v_pk_mul_f32 v[16:17], v[28:29], v[28:29]
    v_pk_mul_f32 v[20:21], v[30:31], v[30:31]
    v_pk_fma_f32 v[16:17], v[32:33], v[32:33], v[16:17]
    v_pk_fma_f32 v[20:21], v[34:35], v[34:35], v[20:21]
    v_pk_fma_f32 v[16:17], v[36:37], v[36:37], v[16:17]
    v_pk_fma_f32 v[20:21], v[38:39], v[38:39], v[20:21]
    v_pk_fma_f32 v[16:17], v[40:41], v[40:41], v[16:17]
    v_pk_fma_f32 v[20:21], v[42:43], v[42:43], v[20:21]
    v_pk_add_f32 v[16:17], v[16:17], v[20:21]
    v_add_f32 v22, v16, v17
    s_nop 1
    v_add_f32_dpp v22, v22, v22 row_ror:8 row_mask:0xf bank_mask:0xf
    s_nop 1
    v_add_f32_dpp v22, v22, v22 row_ror:4 row_mask:0xf bank_mask:0xf
    s_nop 1
    v_add_f32_dpp v22, v22, v22 row_ror:2 row_mask:0xf bank_mask:0xf
    s_nop 1
    v_add_f32_dpp v22, v22, v22 row_ror:1 row_mask:0xf bank_mask:0xf
    v_mov_b32 v45, v22
    s_nop 1
    v_permlane16_swap_b32 v22, v45
    v_add_f32 v22, v22, v45
    v_mov_b32 v45, v22
    s_nop 1
    v_permlane32_swap_b32 v22, v45
    v_add_f32 v22, v22, v45
    v_mul_f32 v22, 0x3a800000, v22
    v_cvt_pk_bf16_f32 v45, v44, v22
    v_lshl_or_b32 v26, v45, 16, 1
    v_and_b32 v22, 0xffff0000, v45
    v_add_f32 v22, 0x3727c5ac, v22
    v_cvt_pk_bf16_f32 v22, v22, v22
    v_and_b32 v22, 0xffff0000, v22
    v_sqrt_f32 v22, v22
    s_nop 0
    v_cvt_pk_bf16_f32 v22, v22, v22
    v_and_b32 v22, 0xffff0000, v22
    v_rcp_f32 v27, v22
    s_waitcnt vmcnt(0)
    v_add_u32 v24, 0x7f4a7c15, v24
    v_add_u32 v25, 0x9e3779b9, v25
    s_mov_b64 exec, 1
    ds_write_b128 v8, v[24:27] offset:7312
    s_mov_b64 exec, -1
    s_branch L_Cj
L_Cn0:
    s_mov_b32 s6, 0x10000000
    s_mov_b32 s7, 0x20000
    s_mov_b32 s10, 2048
    s_mov_b32 s11, 0x20000
    s_lshl_b32 s60, s61, 5
    s_add_u32 s60, s60, s62
    v_mov_b32 v8, 65536
    v_mov_b32 v9, 1
    v_mov_b32 v16, 0
    v_mov_b32 v17, 0
    v_mov_b32 v18, 0
    v_mov_b32 v19, 0
    ds_write_b128 v8, v[16:19] offset:7296
    ds_write_b128 v8, v[16:19] offset:7312
    ds_write_b128 v8, v[16:19] offset:7328
    s_waitcnt lgkmcnt(0)
    s_barrier
L_Cj:
    s_cmp_ge_u32 s61, 4
    s_cbranch_scc1 L_CF
    s_lshl_b32 s50, s61, 14
    s_add_u32 s50, s50, 65536
    s_and_b32 s40, s62, 3
    s_lshl_b32 s40, s40, 10
    s_add_u32 s51, s50, s40
    s_lshr_b32 s40, s62, 2
    s_lshl_b32 s40, s40, 7
    s_add_u32 s51, s51, s40
    s_lshl_b32 s49, s61, 12
    s_lshl_b32 s40, s3, 10
    s_add_u32 s49, s49, s40
    s_add_u32 s49, s49, 147456
    s_lshl_b32 s40, s3, 12
    s_add_u32 s50, s50, s40
    v_lshrrev_b32 v11, 3, v1
    v_lshlrev_b32 v11, 12, v11
    v_and_b32 v10, 7, v1
    v_lshl_or_b32 v11, v10, 4, v11
    v_mov_b32 v13, 0xff
    s_mov_b32 s44, 0
L_tg6:
    ds_read_b128 v[16:19], v8 offset:7312
    s_waitcnt lgkmcnt(0)
    v_readfirstlane_b32 s45, v18
    v_readfirstlane_b32 s38, v16
    v_readfirstlane_b32 s39, v17
    s_bitcmp1_b32 s45, 0
    s_cbranch_scc1 L_tg6_ok
    s_sleep 1
    s_add_u32 s44, s44, 1
    s_cmp_lt_u32 s44, 1600000
    s_cbranch_scc1 L_tg6
L_tg6_ok:
    s_and_b32 s30, s38, 0xfff
    s_bfe_u32 s31, s38, 0xc000c
    s_and_b32 s32, s39, 0xfff
    s_bfe_u32 s33, s39, 0xc000c
    s_cmp_lg_u32 s3, 1
    s_cbranch_scc1 L_Aq
    v_and_b32 v12, 0x1f0, v4
    v_add_u32 v12, 66560, v12
    s_mov_b32 s44, 0
L_lw7:
    ds_read_b32 v10, v8 offset:7296
    ds_read_b128 v[16:19], v12 offset:0
    ds_read_b128 v[20:23], v12 offset:512
    ds_read_b128 v[24:27], v12 offset:1024
    ds_read_b128 v[28:31], v12 offset:1536
    s_waitcnt lgkmcnt(0)
    v_readfirstlane_b32 s45, v10
    s_nop 0
    s_cmp_ge_u32 s45, 4
    s_cbranch_scc1 L_lw7_ok
    s_sleep 1
    s_add_u32 s44, s44, 1
    s_cmp_lt_u32 s44, 1600000
    s_cbranch_scc1 L_lw7
L_lw7_ok:
    s_mov_b32 exec_hi, 0
    v_pk_add_f32 v[16:17], v[16:17], v[20:21]
    v_pk_add_f32 v[18:19], v[18:19], v[22:23]
    v_pk_add_f32 v[24:25], v[24:25], v[28:29]
    v_pk_add_f32 v[26:27], v[26:27], v[30:31]
    v_pk_add_f32 v[32:33], v[16:17], v[24:25]
    v_pk_add_f32 v[34:35], v[18:19], v[26:27]
    v_add_u32 v32, 128, v32
    v_add_u32 v33, 128, v33
    v_add_u32 v34, 128, v34
    v_add_u32 v35, 128, v35
    v_bfi_b32 v32, v13, s30, v32
    v_bfi_b32 v33, v13, s31, v33
    v_bfi_b32 v34, v13, s32, v34
    v_bfi_b32 v35, v13, s33, v35
    buffer_store_dwordx4 v[32:35], v11, s[4:7], s51 offen
    s_add_u32 s45, s51, 786432
    buffer_store_dwordx4 v[32:35], v11, s[4:7], s45 offen sc1
    s_mov_b64 exec, -1
L_Aq:
    v_bfe_u32 v2, v1, 1, 2
    v_lshlrev_b32 v2, 7, v2
    v_lshrrev_b32 v3, 3, v1
    v_lshl_or_b32 v2, v3, 4, v2
    v_and_b32 v3, 1, v1
    v_lshl_or_b32 v2, v3, 3, v2
    s_lshl_b32 s40, s3, 9
    s_add_u32 s40, s40, 65536
    v_add_u32 v2, s40, v2
    v_and_b32 v10, 7, v7
    v_lshlrev_b32 v12, 7, v6
    v_lshl_or_b32 v12, v10, 4, v12
    v_lshrrev_b32 v5, 3, v7
    v_lshl_add_u32 v3, v5, 3, v12
    v_add_u32 v3, s40, v3
    v_add_u32 v12, 65536, v12
    v_lshl_add_u32 v0, v5, 10, v12
    v_lshlrev_b32 v11, 14, v10
    v_lshl_or_b32 v11, v5, 6, v11
    v_lshl_or_b32 v11, v6, 4, v11
    s_lshl_b32 s53, s61, 17
    s_lshl_b32 s40, s3, 12
    s_add_u32 s53, s53, s40
    s_and_b32 s40, s62, 3
    s_lshl_b32 s40, s40, 10
    s_add_u32 s53, s53, s40
    s_lshr_b32 s40, s62, 2
    s_lshl_b32 s40, s40, 7
    s_add_u32 s53, s53, s40
    s_add_u32 s53, s53, 262144
    s_lshl_b32 s52, s61, 12
    s_lshl_b32 s40, s62, 4
    s_add_u32 s52, s52, s40
    s_add_u32 s52, s52, 131072
    v_mov_b32 v13, 0xfff
    v_cmp_gt_u32 s[54:55], 8, v7
    v_lshrrev_b32 v14, 2, v1
    v_lshlrev_b32 v14, 8, v14
    v_bfe_u32 v15, v1, 1, 4
    v_lshl_or_b32 v14, v15, 4, v14
    v_and_b32 v15, 1, v1
    v_lshl_or_b32 v14, v15, 3, v14
    s_lshl_b32 s40, s3, 6
    v_xor_b32 v14, s40, v14
    v_xor_b32 v15, 32, v14
    v_xor_b32 v56, v6, v7
    v_lshlrev_b32 v56, 4, v56
    v_lshl_or_b32 v56, v7, 8, v56
    s_lshl_b32 s40, s3, 13
    v_add_u32 v56, s40, v56
    v_xor_b32 v57, 64, v56
    v_xor_b32 v58, 128, v56
    v_xor_b32 v59, 192, v56
    s_mov_b32 s40, 0x3db504f3
    s_mov_b32 s41, 0x3fb8aa3b
    s_mov_b32 s44, 0
L_lw8:
    ds_read_b32 v10, v8 offset:7336
    s_waitcnt lgkmcnt(0)
    v_readfirstlane_b32 s45, v10
    s_nop 0
    s_cmp_ge_u32 s45, 4
    s_cbranch_scc1 L_lw8_ok
    s_sleep 1
    s_add_u32 s44, s44, 1
    s_cmp_lt_u32 s44, 1600000
    s_cbranch_scc1 L_lw8
L_lw8_ok:
    s_and_b32 s34, s30, 255
    s_and_b32 s35, s31, 255
    s_and_b32 s36, s32, 255
    s_and_b32 s37, s33, 255
    s_mov_b32 s46, s50
    buffer_load_dwordx4 v[52:55], v4, s[4:7], s49 offen offset:0 sc1
    buffer_load_dwordx4 v[36:39], v4, s[4:7], s46 offen offset:0 sc1
    buffer_load_dwordx4 v[40:43], v4, s[4:7], s46 offen offset:1024 sc1
    buffer_load_dwordx4 v[44:47], v4, s[4:7], s46 offen offset:2048 sc1
    buffer_load_dwordx4 v[48:51], v4, s[4:7], s46 offen offset:3072 sc1
    s_mov_b32 s44, 0
L_lw10:
    ds_read_b32 v10, v8 offset:7300
    s_waitcnt lgkmcnt(0)
    v_readfirstlane_b32 s45, v10
    s_nop 0
    s_cmp_ge_u32 s45, 4
    s_cbranch_scc1 L_lw10_ok
    s_sleep 1
    s_add_u32 s44, s44, 1
    s_cmp_lt_u32 s44, 1600000
    s_cbranch_scc1 L_lw10
L_lw10_ok:
    ds_read_b128 v[64:67], v56 offset:0
    ds_read_b128 v[68:71], v57 offset:0
    ds_read_b128 v[72:75], v58 offset:0
    ds_read_b128 v[76:79], v59 offset:0
    ds_read_b128 v[80:83], v56 offset:4096
    ds_read_b128 v[84:87], v57 offset:4096
    ds_read_b128 v[88:91], v58 offset:4096
    ds_read_b128 v[92:95], v59 offset:4096
    s_mov_b32 s44, 0
    s_branch L_poll9_w
L_poll9:
    buffer_load_dwordx4 v[52:55], v4, s[4:7], s49 offen offset:0 sc1
    buffer_load_dwordx4 v[36:39], v4, s[4:7], s46 offen offset:0 sc1
    buffer_load_dwordx4 v[40:43], v4, s[4:7], s46 offen offset:1024 sc1
    buffer_load_dwordx4 v[44:47], v4, s[4:7], s46 offen offset:2048 sc1
    buffer_load_dwordx4 v[48:51], v4, s[4:7], s46 offen offset:3072 sc1
L_poll9_w:
    s_waitcnt vmcnt(0)
L_poll9_c:
    v_xor_b32 v36, s34, v36
    v_xor_b32 v37, s35, v37
    v_xor_b32 v38, s36, v38
    v_xor_b32 v39, s37, v39
    v_xor_b32 v40, s34, v40
    v_xor_b32 v41, s35, v41
    v_xor_b32 v42, s36, v42
    v_xor_b32 v43, s37, v43
    v_xor_b32 v44, s34, v44
    v_xor_b32 v45, s35, v45
    v_xor_b32 v46, s36, v46
    v_xor_b32 v47, s37, v47
    v_xor_b32 v48, s34, v48
    v_xor_b32 v49, s35, v49
    v_xor_b32 v50, s36, v50
    v_xor_b32 v51, s37, v51
    v_xor_b32 v52, s34, v52
    v_xor_b32 v53, s35, v53
    v_xor_b32 v54, s36, v54
    v_xor_b32 v55, s37, v55
    v_or3_b32 v10, v36, v37, v38
    v_or3_b32 v10, v10, v39, v40
    v_or3_b32 v10, v10, v41, v42
    v_or3_b32 v10, v10, v43, v44
    v_or3_b32 v10, v10, v45, v46
    v_or3_b32 v10, v10, v47, v48
    v_or3_b32 v10, v10, v49, v50
    v_or3_b32 v10, v10, v51, v52
    v_or3_b32 v10, v10, v53, v54
    v_or_b32 v10, v10, v55
    v_and_b32 v10, 255, v10
    v_cmp_ne_u32 vcc, 0, v10
    s_nop 0
    s_and_b64 exec, vcc, exec
    s_cbranch_scc0 L_poll9_ok
    s_sleep 2
    s_add_u32 s44, s44, 1
    s_and_b32 s45, s44, 3
    s_cmp_eq_u32 s45, 3
    s_cselect_b32 s45, 786432, 0
    s_add_u32 s46, s50, s45
    s_cmp_lt_u32 s44, 200000
    s_cbranch_scc1 L_poll9
L_poll9_ok:
    s_mov_b64 exec, -1
    v_pk_add_f32 v[48:49], v[48:49], v[52:53]
    v_pk_add_f32 v[50:51], v[50:51], v[54:55]
    v_pk_add_f32 v[36:37], v[36:37], v[40:41]
    v_pk_add_f32 v[38:39], v[38:39], v[42:43]
    v_pk_add_f32 v[44:45], v[44:45], v[48:49]
    v_pk_add_f32 v[46:47], v[46:47], v[50:51]
    v_pk_add_f32 v[36:37], v[36:37], v[44:45]
    v_pk_add_f32 v[38:39], v[38:39], v[46:47]
    v_cvt_pk_bf16_f32 v16, v36, v37
    v_cvt_pk_bf16_f32 v17, v38, v39
    ds_write_b64 v2, v[16:17] offset:3072
    s_mov_b64 exec, 1
    ds_add_u32 v8, v9 offset:7308
    s_mov_b64 exec, -1
    s_mov_b32 s44, 0
L_lw11:
    ds_read_b32 v10, v8 offset:7308
    ds_read_b128 v[16:19], v12 offset:3072
    ds_read_b128 v[20:23], v12 offset:3584
    ds_read_b128 v[24:27], v12 offset:4096
    ds_read_b128 v[28:31], v12 offset:4608
    s_waitcnt lgkmcnt(0)
    v_readfirstlane_b32 s45, v10
    s_nop 0
    s_cmp_ge_u32 s45, 4
    s_cbranch_scc1 L_lw11_ok
    s_add_u32 s44, s44, 1
    s_cmp_lt_u32 s44, 1600000
    s_cbranch_scc1 L_lw11
L_lw11_ok:
    v_mfma_f32_16x16x32_bf16 v[32:35], v[64:67], v[16:19], 0
    v_mfma_f32_16x16x32_bf16 v[36:39], v[80:83], v[16:19], 0
    v_mfma_f32_16x16x32_bf16 v[32:35], v[68:71], v[20:23], v[32:35]
    v_mfma_f32_16x16x32_bf16 v[36:39], v[84:87], v[20:23], v[36:39]
    v_mfma_f32_16x16x32_bf16 v[32:35], v[72:75], v[24:27], v[32:35]
    v_mfma_f32_16x16x32_bf16 v[36:39], v[88:91], v[24:27], v[36:39]
    v_mfma_f32_16x16x32_bf16 v[32:35], v[76:79], v[28:31], v[32:35]
    v_mfma_f32_16x16x32_bf16 v[36:39], v[92:95], v[28:31], v[36:39]
    s_nop 7
    v_cndmask_b32 v40, v36, v32, s[54:55]
    v_cndmask_b32 v41, v37, v33, s[54:55]
    v_cndmask_b32 v42, v38, v34, s[54:55]
    v_cndmask_b32 v43, v39, v35, s[54:55]
    v_cvt_pk_bf16_f32 v44, v40, v41
    v_cvt_pk_bf16_f32 v45, v42, v43
    v_lshlrev_b32 v40, 16, v44
    v_and_b32 v41, 0xffff0000, v44
    v_lshlrev_b32 v42, 16, v45
    v_and_b32 v43, 0xffff0000, v45
    v_mul_f32 v40, s40, v40
    v_mul_f32 v41, s40, v41
    v_mul_f32 v42, s40, v42
    v_mul_f32 v43, s40, v43
    v_cvt_pk_bf16_f32 v44, v40, v41
    v_cvt_pk_bf16_f32 v45, v42, v43
    ds_write_b64 v3, v[44:45] offset:5120
    s_mov_b64 exec, 1
    ds_add_u32 v8, v9 offset:7328
    s_mov_b64 exec, -1
    s_mov_b32 s44, 0
L_lw12:
    ds_read_b32 v10, v8 offset:7328
    ds_read_b128 v[16:19], v0 offset:5120
    ds_read_b128 v[20:23], v0 offset:5632
    s_waitcnt lgkmcnt(0)
    v_readfirstlane_b32 s45, v10
    s_nop 0
    s_cmp_ge_u32 s45, 4
    s_cbranch_scc1 L_lw12_ok
    s_add_u32 s44, s44, 1
    s_cmp_lt_u32 s44, 1600000
    s_cbranch_scc1 L_lw12
L_lw12_ok:
    v_lshlrev_b32 v32, 16, v16
    v_and_b32 v33, 0xffff0000, v16
    v_lshlrev_b32 v34, 16, v17
    v_and_b32 v35, 0xffff0000, v17
    v_lshlrev_b32 v36, 16, v18
    v_and_b32 v37, 0xffff0000, v18
    v_lshlrev_b32 v38, 16, v19
    v_and_b32 v39, 0xffff0000, v19
    v_lshlrev_b32 v40, 16, v20
    v_and_b32 v41, 0xffff0000, v20
    v_lshlrev_b32 v42, 16, v21
    v_and_b32 v43, 0xffff0000, v21
    v_lshlrev_b32 v44, 16, v22
    v_and_b32 v45, 0xffff0000, v22
    v_lshlrev_b32 v46, 16, v23
    v_and_b32 v47, 0xffff0000, v23
    v_max3_f32 v60, v32, v33, v34
    v_max3_f32 v24, v35, v36, v37
    v_max3_f32 v25, v38, v39, v40
    v_max3_f32 v26, v41, v42, v43
    v_max3_f32 v60, v60, v44, v45
    v_max3_f32 v24, v24, v46, v47
    v_max3_f32 v60, v60, v25, v26
    v_max_f32 v60, v60, v24
    v_mov_b32 v26, s41
    v_mov_b32 v27, s41
    v_max_f32_dpp v60, v60, v60 row_ror:8 row_mask:0xf bank_mask:0xf
    v_mov_b32 v24, v60
    s_nop 1
    v_permlane16_swap_b32 v60, v24
    v_max_f32 v60, v60, v24
    v_mov_b32 v24, v60
    s_nop 1
    v_permlane32_swap_b32 v60, v24
    v_max_f32 v60, v60, v24
    v_mul_f32 v24, s41, v60
    v_mul_f32 v25, s41, v60
    v_pk_fma_f32 v[32:33], v[32:33], v[26:27], v[24:25] neg_lo:[0,0,1] neg_hi:[0,0,1]
    v_pk_fma_f32 v[34:35], v[34:35], v[26:27], v[24:25] neg_lo:[0,0,1] neg_hi:[0,0,1]
    v_pk_fma_f32 v[36:37], v[36:37], v[26:27], v[24:25] neg_lo:[0,0,1] neg_hi:[0,0,1]
    v_pk_fma_f32 v[38:39], v[38:39], v[26:27], v[24:25] neg_lo:[0,0,1] neg_hi:[0,0,1]
    v_pk_fma_f32 v[40:41], v[40:41], v[26:27], v[24:25] neg_lo:[0,0,1] neg_hi:[0,0,1]
    v_pk_fma_f32 v[42:43], v[42:43], v[26:27], v[24:25] neg_lo:[0,0,1] neg_hi:[0,0,1]
    v_pk_fma_f32 v[44:45], v[44:45], v[26:27], v[24:25] neg_lo:[0,0,1] neg_hi:[0,0,1]
    v_pk_fma_f32 v[46:47], v[46:47], v[26:27], v[24:25] neg_lo:[0,0,1] neg_hi:[0,0,1]
    v_exp_f32 v32, v32
    v_exp_f32 v33, v33
    v_exp_f32 v34, v34
    v_exp_f32 v35, v35
    v_cvt_pk_bf16_f32 v16, v32, v33
    v_exp_f32 v36, v36
    v_exp_f32 v37, v37
    v_cvt_pk_bf16_f32 v17, v34, v35
    v_exp_f32 v38, v38
    v_exp_f32 v39, v39
    v_cvt_pk_bf16_f32 v18, v36, v37
    v_exp_f32 v40, v40
    v_exp_f32 v41, v41
    v_cvt_pk_bf16_f32 v19, v38, v39
    v_exp_f32 v42, v42
    v_exp_f32 v43, v43
    v_cvt_pk_bf16_f32 v20, v40, v41
    v_exp_f32 v44, v44
    v_exp_f32 v45, v45
    v_cvt_pk_bf16_f32 v21, v42, v43
    v_exp_f32 v46, v46
    v_exp_f32 v47, v47
    v_cvt_pk_bf16_f32 v22, v44, v45
    v_cvt_pk_bf16_f32 v23, v46, v47
    s_cmp_lg_u32 s3, 3
    s_cbranch_scc1 L_Apv
    v_pk_add_f32 v[32:33], v[32:33], v[34:35]
    v_pk_add_f32 v[36:37], v[36:37], v[38:39]
    v_pk_add_f32 v[40:41], v[40:41], v[42:43]
    v_pk_add_f32 v[44:45], v[44:45], v[46:47]
    v_pk_add_f32 v[32:33], v[32:33], v[36:37]
    v_pk_add_f32 v[40:41], v[40:41], v[44:45]
    v_pk_add_f32 v[32:33], v[32:33], v[40:41]
    v_add_f32 v61, v32, v33
    s_nop 1
    v_add_f32_dpp v61, v61, v61 row_ror:8 row_mask:0xf bank_mask:0xf
    v_mov_b32 v48, v61
    s_nop 1
    v_permlane16_swap_b32 v61, v48
    v_add_f32 v61, v61, v48
    v_mov_b32 v48, v61
    s_nop 1
    v_permlane32_swap_b32 v61, v48
    v_add_f32 v61, v61, v48
    v_mov_b32 v62, v60
    v_mov_b32 v63, v61
    v_bfi_b32 v60, v13, s30, v60
    v_bfi_b32 v61, v13, s31, v61
    v_bfi_b32 v62, v13, s32, v62
    v_bfi_b32 v63, v13, s33, v63
    s_mov_b64 exec, 0xff
    v_lshlrev_b32 v48, 9, v1
    buffer_store_dwordx4 v[60:63], v48, s[4:7], s52 offen
    s_add_u32 s45, s52, 786432
    buffer_store_dwordx4 v[60:63], v48, s[4:7], s45 offen sc1
    s_mov_b64 exec, -1
L_Apv:
    s_mov_b32 s44, 0
L_lw13:
    ds_read_b32 v10, v8 offset:7304
    s_waitcnt lgkmcnt(0)
    v_readfirstlane_b32 s45, v10
    s_nop 0
    s_cmp_ge_u32 s45, 4
    s_cbranch_scc1 L_lw13_ok
    s_add_u32 s44, s44, 1
    s_cmp_lt_u32 s44, 1600000
    s_cbranch_scc1 L_lw13
L_lw13_ok:
    ds_read_b64_tr_b16 v[96:97], v14 offset:32768
    ds_read_b64_tr_b16 v[98:99], v14 offset:36864
    ds_read_b64_tr_b16 v[100:101], v15 offset:32768
    ds_read_b64_tr_b16 v[102:103], v15 offset:36864
    ds_read_b64_tr_b16 v[104:105], v14 offset:40960
    ds_read_b64_tr_b16 v[106:107], v14 offset:45056
    ds_read_b64_tr_b16 v[108:109], v15 offset:40960
    ds_read_b64_tr_b16 v[110:111], v15 offset:45056
    ds_read_b64_tr_b16 v[112:113], v14 offset:49152
    ds_read_b64_tr_b16 v[114:115], v14 offset:53248
    ds_read_b64_tr_b16 v[116:117], v15 offset:49152
    ds_read_b64_tr_b16 v[118:119], v15 offset:53248
    s_waitcnt lgkmcnt(8)
    ds_read_b64_tr_b16 v[120:121], v14 offset:57344
    ds_read_b64_tr_b16 v[122:123], v14 offset:61440
    ds_read_b64_tr_b16 v[124:125], v15 offset:57344
    ds_read_b64_tr_b16 v[126:127], v15 offset:61440
    s_waitcnt lgkmcnt(12)
    v_mfma_f32_16x16x32_bf16 v[64:67], v[96:99], v[16:19], 0
    v_mfma_f32_16x16x32_bf16 v[68:71], v[100:103], v[16:19], 0
    s_waitcnt lgkmcnt(8)
    v_mfma_f32_16x16x32_bf16 v[64:67], v[104:107], v[20:23], v[64:67]
    v_mfma_f32_16x16x32_bf16 v[68:71], v[108:111], v[20:23], v[68:71]
    s_waitcnt lgkmcnt(4)
    v_mfma_f32_16x16x32_bf16 v[72:75], v[112:115], v[16:19], 0
    v_mfma_f32_16x16x32_bf16 v[76:79], v[116:119], v[16:19], 0
    s_waitcnt lgkmcnt(0)
    v_mfma_f32_16x16x32_bf16 v[72:75], v[120:123], v[20:23], v[72:75]
    v_mfma_f32_16x16x32_bf16 v[76:79], v[124:127], v[20:23], v[76:79]
    s_nop 6
    v_cndmask_b32 v68, v72, v68, s[54:55]
    v_cndmask_b32 v69, v73, v69, s[54:55]
    v_cndmask_b32 v70, v74, v70, s[54:55]
    v_cndmask_b32 v71, v75, v71, s[54:55]
    v_cndmask_b32 v64, v76, v64, s[54:55]
    v_cndmask_b32 v65, v77, v65, s[54:55]
    v_cndmask_b32 v66, v78, v66, s[54:55]
    v_cndmask_b32 v67, v79, v67, s[54:55]
    v_add_f32_dpp v64, v68, v64 row_ror:8 row_mask:0xf bank_mask:0xf
    v_add_f32_dpp v65, v69, v65 row_ror:8 row_mask:0xf bank_mask:0xf
    v_add_f32_dpp v66, v70, v66 row_ror:8 row_mask:0xf bank_mask:0xf
    v_add_f32_dpp v67, v71, v67 row_ror:8 row_mask:0xf bank_mask:0xf
    v_bfi_b32 v64, v13, s30, v64
    v_bfi_b32 v65, v13, s31, v65
    v_bfi_b32 v66, v13, s32, v66
    v_bfi_b32 v67, v13, s33, v67
    buffer_store_dwordx4 v[64:67], v11, s[4:7], s53 offen
    s_add_u32 s45, s53, 786432
    buffer_store_dwordx4 v[64:67], v11, s[4:7], s45 offen sc1
    s_cmp_eq_u32 s3, 2
    s_cbranch_scc1 L_RED
    s_cmp_eq_u32 s3, 3
    s_cbranch_scc1 L_fin
    s_lshr_b32 s50, s60, 1
    s_lshl_b32 s50, s50, 13
    s_lshl_b32 s40, s3, 12
    s_add_u32 s50, s50, s40
    s_add_u32 s50, s50, 262144
    s_lshl_b32 s51, s61, 12
    s_lshr_b32 s40, s62, 2
    s_lshl_b32 s40, s40, 9
    s_add_u32 s51, s51, s40
    s_add_u32 s51, s51, 131072
    v_lshrrev_b32 v2, 3, v1
    v_lshlrev_b32 v2, 2, v2
    v_and_b32 v3, 3, v1
    v_or_b32 v2, v2, v3
    v_lshlrev_b32 v2, 4, v2
    v_and_b32 v12, 7, v1
    v_lshlrev_b32 v12, 3, v12
    v_lshrrev_b32 v3, 5, v1
    v_lshl_or_b32 v12, v3, 1, v12
    v_bfe_u32 v3, v1, 4, 1
    v_lshl_or_b32 v12, v3, 2, v12
    s_lshl_b32 s40, s3, 6
    s_add_u32 s40, s40, 72704
    v_add_u32 v12, s40, v12
    s_mov_b32 s44, 0
L_lw14:
    ds_read_b32 v10, v8 offset:7340
    s_waitcnt lgkmcnt(0)
    v_readfirstlane_b32 s45, v10
    s_nop 0
    s_cmp_ge_u32 s45, 4
    s_cbranch_scc1 L_lw14_ok
    s_sleep 1
    s_add_u32 s44, s44, 1
    s_cmp_lt_u32 s44, 1600000
    s_cbranch_scc1 L_lw14
L_lw14_ok:
    s_mov_b32 s43, 0
    s_and_b32 s34, s30, 4095
    s_and_b32 s35, s31, 4095
    s_and_b32 s36, s32, 4095
    s_and_b32 s37, s33, 4095
    s_mov_b32 s46, s50
    s_mov_b32 s47, s51
    buffer_load_dwordx4 v[72:75], v2, s[4:7], s47 offen sc1
    buffer_load_dwordx4 v[76:79], v4, s[4:7], s46 offen offset:0 sc1
    buffer_load_dwordx4 v[80:83], v4, s[4:7], s46 offen offset:1024 sc1
    buffer_load_dwordx4 v[84:87], v4, s[4:7], s46 offen offset:2048 sc1
    buffer_load_dwordx4 v[88:91], v4, s[4:7], s46 offen offset:3072 sc1
    s_mov_b32 s44, 0
L_lw16:
    ds_read_b32 v10, v8 offset:7340
    s_waitcnt lgkmcnt(0)
    v_readfirstlane_b32 s45, v10
    s_nop 0
    s_cmp_ge_u32 s45, 8
    s_cbranch_scc1 L_lw16_ok
    s_sleep 1
    s_add_u32 s44, s44, 1
    s_cmp_lt_u32 s44, 1600000
    s_cbranch_scc1 L_lw16
L_lw16_ok:
    buffer_load_dwordx4 v[92:95], v2, s[4:7], s47 offen sc1
    buffer_load_dwordx4 v[96:99], v4, s[4:7], s46 offen offset:0 sc1
    buffer_load_dwordx4 v[100:103], v4, s[4:7], s46 offen offset:1024 sc1
    buffer_load_dwordx4 v[104:107], v4, s[4:7], s46 offen offset:2048 sc1
    buffer_load_dwordx4 v[108:111], v4, s[4:7], s46 offen offset:3072 sc1
    s_mov_b32 s44, 0
L_pp15:
    s_waitcnt vmcnt(5)
    v_xor_b32 v16, s34, v72
    v_xor_b32 v17, s35, v73
    v_xor_b32 v18, s36, v74
    v_xor_b32 v19, s37, v75
    v_xor_b32 v20, s34, v76
    v_xor_b32 v21, s35, v77
    v_xor_b32 v22, s36, v78
    v_xor_b32 v23, s37, v79
    v_xor_b32 v24, s34, v80
    v_xor_b32 v25, s35, v81
    v_xor_b32 v26, s36, v82
    v_xor_b32 v27, s37, v83
    v_xor_b32 v28, s34, v84
    v_xor_b32 v29, s35, v85
    v_xor_b32 v30, s36, v86
    v_xor_b32 v31, s37, v87
    v_xor_b32 v32, s34, v88
    v_xor_b32 v33, s35, v89
    v_xor_b32 v34, s36, v90
    v_xor_b32 v35, s37, v91
    v_or3_b32 v10, v16, v17, v18
    v_or3_b32 v10, v10, v19, v20
    v_or3_b32 v10, v10, v21, v22
    v_or3_b32 v10, v10, v23, v24
    v_or3_b32 v10, v10, v25, v26
    v_or3_b32 v10, v10, v27, v28
    v_or3_b32 v10, v10, v29, v30
    v_or3_b32 v10, v10, v31, v32
    v_or3_b32 v10, v10, v33, v34
    v_or_b32 v10, v10, v35
    v_and_b32 v10, 4095, v10
    v_cmp_ne_u32 vcc, 0, v10
    s_nop 0
    s_and_b64 exec, vcc, exec
    s_cbranch_scc0 L_pp15_ok
    buffer_load_dwordx4 v[72:75], v2, s[4:7], s47 offen sc1
    buffer_load_dwordx4 v[76:79], v4, s[4:7], s46 offen offset:0 sc1
    buffer_load_dwordx4 v[80:83], v4, s[4:7], s46 offen offset:1024 sc1
    buffer_load_dwordx4 v[84:87], v4, s[4:7], s46 offen offset:2048 sc1
    buffer_load_dwordx4 v[88:91], v4, s[4:7], s46 offen offset:3072 sc1
    s_waitcnt vmcnt(5)
    v_xor_b32 v16, s34, v92
    v_xor_b32 v17, s35, v93
    v_xor_b32 v18, s36, v94
    v_xor_b32 v19, s37, v95
    v_xor_b32 v20, s34, v96
    v_xor_b32 v21, s35, v97
    v_xor_b32 v22, s36, v98
    v_xor_b32 v23, s37, v99
    v_xor_b32 v24, s34, v100
    v_xor_b32 v25, s35, v101
    v_xor_b32 v26, s36, v102
    v_xor_b32 v27, s37, v103
    v_xor_b32 v28, s34, v104
    v_xor_b32 v29, s35, v105
    v_xor_b32 v30, s36, v106
    v_xor_b32 v31, s37, v107
    v_xor_b32 v32, s34, v108
    v_xor_b32 v33, s35, v109
    v_xor_b32 v34, s36, v110
    v_xor_b32 v35, s37, v111
    v_or3_b32 v10, v16, v17, v18
    v_or3_b32 v10, v10, v19, v20
    v_or3_b32 v10, v10, v21, v22
    v_or3_b32 v10, v10, v23, v24
    v_or3_b32 v10, v10, v25, v26
    v_or3_b32 v10, v10, v27, v28
    v_or3_b32 v10, v10, v29, v30
    v_or3_b32 v10, v10, v31, v32
    v_or3_b32 v10, v10, v33, v34
    v_or_b32 v10, v10, v35
    v_and_b32 v10, 4095, v10
    v_cmp_ne_u32 vcc, 0, v10
    s_nop 0
    s_and_b64 exec, vcc, exec
    s_cbranch_scc0 L_pp15_ok
    buffer_load_dwordx4 v[92:95], v2, s[4:7], s47 offen sc1
    buffer_load_dwordx4 v[96:99], v4, s[4:7], s46 offen offset:0 sc1
    buffer_load_dwordx4 v[100:103], v4, s[4:7], s46 offen offset:1024 sc1
    buffer_load_dwordx4 v[104:107], v4, s[4:7], s46 offen offset:2048 sc1
    buffer_load_dwordx4 v[108:111], v4, s[4:7], s46 offen offset:3072 sc1
    s_add_u32 s44, s44, 1
    s_and_b32 s45, s44, 1
    s_cselect_b32 s45, 786432, 0
    s_add_u32 s46, s50, s45
    s_add_u32 s47, s51, s45
    s_cmp_lt_u32 s44, 200000
    s_cbranch_scc1 L_pp15
L_pp15_ok:
    s_mov_b64 exec, -1
    v_max_f32_dpp v18, v18, v18 row_ror:8 row_mask:0xf bank_mask:0xf
    s_nop 1
    v_max_f32_dpp v18, v18, v18 row_ror:2 row_mask:0xf bank_mask:0xf
    s_nop 1
    v_max_f32_dpp v18, v18, v18 row_ror:1 row_mask:0xf bank_mask:0xf
    v_mov_b32 v10, v18
    s_nop 1
    v_permlane16_swap_b32 v18, v10
    v_max_f32 v18, v18, v10
    v_mov_b32 v10, v18
    s_nop 1
    v_permlane32_swap_b32 v18, v10
    v_max_f32 v18, v18, v10
    v_sub_f32 v16, v16, v18
    v_mul_f32 v16, s41, v16
    v_exp_f32 v16, v16
    s_nop 0
    v_mul_f32 v17, v16, v17
    v_mul_f32_dpp v40, v16, v20 quad_perm:[0,0,0,0] row_mask:0xf bank_mask:0xf
    v_mul_f32_dpp v41, v16, v21 quad_perm:[0,0,0,0] row_mask:0xf bank_mask:0xf
    v_add_f32_dpp v17, v17, v17 row_ror:8 row_mask:0xf bank_mask:0xf
    v_mul_f32_dpp v42, v16, v22 quad_perm:[0,0,0,0] row_mask:0xf bank_mask:0xf
    v_mul_f32_dpp v43, v16, v23 quad_perm:[0,0,0,0] row_mask:0xf bank_mask:0xf
    v_add_f32_dpp v17, v17, v17 row_ror:2 row_mask:0xf bank_mask:0xf
    v_fmac_f32_dpp v40, v16, v24 quad_perm:[1,1,1,1] row_mask:0xf bank_mask:0xf
    v_fmac_f32_dpp v41, v16, v25 quad_perm:[1,1,1,1] row_mask:0xf bank_mask:0xf
    v_add_f32_dpp v17, v17, v17 row_ror:1 row_mask:0xf bank_mask:0xf
    v_mov_b32 v10, v17
    v_fmac_f32_dpp v42, v16, v26 quad_perm:[1,1,1,1] row_mask:0xf bank_mask:0xf
    v_fmac_f32_dpp v43, v16, v27 quad_perm:[1,1,1,1] row_mask:0xf bank_mask:0xf
    v_permlane16_swap_b32 v17, v10
    v_add_f32 v17, v17, v10
    v_mov_b32 v10, v17
    v_fmac_f32_dpp v40, v16, v28 quad_perm:[2,2,2,2] row_mask:0xf bank_mask:0xf
    v_fmac_f32_dpp v41, v16, v29 quad_perm:[2,2,2,2] row_mask:0xf bank_mask:0xf
    v_permlane32_swap_b32 v17, v10
    v_add_f32 v17, v17, v10
    v_fmac_f32_dpp v42, v16, v30 quad_perm:[2,2,2,2] row_mask:0xf bank_mask:0xf
    v_fmac_f32_dpp v43, v16, v31 quad_perm:[2,2,2,2] row_mask:0xf bank_mask:0xf
    v_rcp_f32 v17, v17
    v_fmac_f32_dpp v40, v16, v32 quad_perm:[3,3,3,3] row_mask:0xf bank_mask:0xf
    v_fmac_f32_dpp v41, v16, v33 quad_perm:[3,3,3,3] row_mask:0xf bank_mask:0xf
    v_fmac_f32_dpp v42, v16, v34 quad_perm:[3,3,3,3] row_mask:0xf bank_mask:0xf
    v_fmac_f32_dpp v43, v16, v35 quad_perm:[3,3,3,3] row_mask:0xf bank_mask:0xf
    v_permlane32_swap_b32 v40, v41
    s_nop 0
    v_permlane32_swap_b32 v42, v43
    v_add_f32 v40, v40, v41
    v_add_f32 v42, v42, v43
    s_nop 1
    v_permlane16_swap_b32 v40, v42
    v_add_f32 v40, v40, v42
    s_nop 1
    v_add_f32_dpp v40, v40, v40 row_ror:8 row_mask:0xf bank_mask:0xf
    v_mul_f32 v40, v40, v17
    v_cvt_pk_bf16_f32 v40, v40, v40
    ds_write_b16 v12, v40
    s_mov_b64 exec, 1
    ds_add_u32 v8, v9 offset:7332
    s_mov_b64 exec, -1
    s_branch L_fin
L_CF:
    s_cmp_eq_u32 s3, 3
    s_cbranch_scc1 L_fin
    s_mov_b32 s44, 0
L_tg17:
    ds_read_b128 v[16:19], v8 offset:7312
    s_waitcnt lgkmcnt(0)
    v_readfirstlane_b32 s45, v18
    v_readfirstlane_b32 s38, v16
    v_readfirstlane_b32 s39, v17
    s_bitcmp1_b32 s45, 0
    s_cbranch_scc1 L_tg17_ok
    s_sleep 1
    s_add_u32 s44, s44, 1
    s_cmp_lt_u32 s44, 1600000
    s_cbranch_scc1 L_tg17
L_tg17_ok:
    s_and_b32 s30, s38, 0xfff
    s_bfe_u32 s31, s38, 0xc000c
    s_and_b32 s32, s39, 0xfff
    s_bfe_u32 s33, s39, 0xc000c
    s_cmp_ge_u32 s3, 2
    s_cbranch_scc1 L_RED
    s_cmp_ge_u32 s62, 24
    s_cselect_b32 s54, 1, 0
    s_lshr_b32 s55, s62, 2
    s_min_u32 s55, s55, 6
    s_add_u32 s40, s54, 1
    s_lshr_b32 s56, s62, s40
    s_and_b32 s56, s56, 1
    s_lshl_b32 s40, s54, 1
    s_add_u32 s40, s40, 1
    s_and_b32 s57, s62, s40
    s_cmp_eq_u32 s3, 1
    s_cbranch_scc1 L_CF1
    s_cmp_eq_u32 s54, 0
    s_cbranch_scc1 L_fin
    v_lshrrev_b32 v11, 3, v1
    v_lshlrev_b32 v11, 10, v11
    v_and_b32 v10, 7, v1
    v_lshl_or_b32 v11, v10, 4, v11
    v_mov_b32 v13, 0xff
    s_sub_u32 s51, s61, 4
    s_lshl_b32 s51, s51, 12
    s_and_b32 s40, s62, 7
    s_lshl_b32 s40, s40, 7
    s_add_u32 s51, s51, s40
    s_add_u32 s51, s51, 147456
    v_and_b32 v12, 0x1f0, v4
    v_add_u32 v12, 68608, v12
    s_mov_b32 s44, 0
L_lw18:
    ds_read_b32 v10, v8 offset:7300
    ds_read_b128 v[16:19], v12 offset:0
    ds_read_b128 v[20:23], v12 offset:512
    ds_read_b128 v[24:27], v12 offset:1024
    ds_read_b128 v[28:31], v12 offset:1536
    s_waitcnt lgkmcnt(0)
    v_readfirstlane_b32 s45, v10
    s_nop 0
    s_cmp_ge_u32 s45, 4
    s_cbranch_scc1 L_lw18_ok
    s_sleep 1
    s_add_u32 s44, s44, 1
    s_cmp_lt_u32 s44, 1600000
    s_cbranch_scc1 L_lw18
L_lw18_ok:
    s_mov_b32 exec_hi, 0
    v_pk_add_f32 v[16:17], v[16:17], v[20:21]
    v_pk_add_f32 v[18:19], v[18:19], v[22:23]
    v_pk_add_f32 v[24:25], v[24:25], v[28:29]
    v_pk_add_f32 v[26:27], v[26:27], v[30:31]
    v_pk_add_f32 v[32:33], v[16:17], v[24:25]
    v_pk_add_f32 v[34:35], v[18:19], v[26:27]
    v_add_u32 v32, 128, v32
    v_add_u32 v33, 128, v33
    v_add_u32 v34, 128, v34
    v_add_u32 v35, 128, v35
    v_bfi_b32 v32, v13, s30, v32
    v_bfi_b32 v33, v13, s31, v33
    v_bfi_b32 v34, v13, s32, v34
    v_bfi_b32 v35, v13, s33, v35
    buffer_store_dwordx4 v[32:35], v11, s[4:7], s51 offen sc1
    s_mov_b64 exec, -1
    s_branch L_fin
L_CF1:
    s_lshl_b32 s40, s55, 5
    v_add_u32 v11, s40, v1
    v_mul_u32_u24 v12, 4682, v11
    v_lshrrev_b32 v12, 16, v12
    v_mul_u32_u24 v13, 14, v12
    v_sub_u32 v11, v11, v13
    v_lshlrev_b32 v12, 10, v12
    v_lshl_or_b32 v11, v11, 4, v12
    v_mov_b32 v13, 0x3ff
    s_sub_u32 s40, s61, 4
    s_lshl_b32 s50, s40, 14
    s_add_u32 s50, s50, 196608
    s_lshl_b32 s49, s40, 12
    s_add_u32 s49, s49, 150528
    s_cmp_ge_u32 s57, 2
    s_cselect_b32 s51, s49, s50
    s_and_b32 s40, s57, 1
    s_lshl_b32 s40, s40, 9
    s_add_u32 s51, s51, s40
    s_lshl_b32 s40, s56, 8
    s_add_u32 s51, s51, s40
    s_lshr_b32 s41, s62, 1
    s_lshl_b32 s40, s41, 10
    s_add_u32 s50, s50, s40
    s_add_u32 s49, s49, s40
    s_mov_b32 s52, 0x3fff3fff
    s_mov_b32 s53, 0x3fff3fff
    v_bfe_u32 v3, v1, 4, 1
    v_lshl_or_b32 v2, v7, 1, v3
    v_mul_u32_u24 v5, 37, v2
    v_lshrrev_b32 v5, 8, v5
    v_add_lshl_u32 v2, v2, v5, 2
    v_lshrrev_b32 v3, 5, v1
    v_lshl_add_u32 v2, v3, 1, v2
    v_add_u32 v2, 72704, v2
    s_mul_i32 s41, s41, 14
    v_add_u32 v10, s41, v7
    v_cmp_lt_u32 vcc, 191, v10
    s_nop 0
    s_mov_b64 s[56:57], vcc
    v_and_b32 v12, 0x1f0, v4
    v_add_u32 v12, 66560, v12
    s_mov_b32 s44, 0
L_lw19:
    ds_read_b32 v10, v8 offset:7296
    ds_read_b128 v[16:19], v12 offset:0
    ds_read_b128 v[20:23], v12 offset:512
    ds_read_b128 v[24:27], v12 offset:1024
    ds_read_b128 v[28:31], v12 offset:1536
    s_waitcnt lgkmcnt(0)
    v_readfirstlane_b32 s45, v10
    s_nop 0
    s_cmp_ge_u32 s45, 4
    s_cbranch_scc1 L_lw19_ok
    s_sleep 1
    s_add_u32 s44, s44, 1
    s_cmp_lt_u32 s44, 1600000
    s_cbranch_scc1 L_lw19
L_lw19_ok:
    s_mov_b32 exec_hi, 0
    v_pk_add_f32 v[16:17], v[16:17], v[20:21]
    v_pk_add_f32 v[18:19], v[18:19], v[22:23]
    v_pk_add_f32 v[24:25], v[24:25], v[28:29]
    v_pk_add_f32 v[26:27], v[26:27], v[30:31]
    v_pk_add_f32 v[32:33], v[16:17], v[24:25]
    v_pk_add_f32 v[34:35], v[18:19], v[26:27]
    v_add_u32 v32, 512, v32
    v_add_u32 v33, 512, v33
    v_add_u32 v34, 512, v34
    v_add_u32 v35, 512, v35
    v_bfi_b32 v32, v13, s30, v32
    v_bfi_b32 v33, v13, s31, v33
    v_bfi_b32 v34, v13, s32, v34
    v_bfi_b32 v35, v13, s33, v35
    buffer_store_dwordx4 v[32:35], v11, s[4:7], s51 offen
    s_add_u32 s45, s51, 786432
    buffer_store_dwordx4 v[32:35], v11, s[4:7], s45 offen sc1
    s_mov_b64 exec, -1
    s_mov_b32 s44, 0
L_lw20:
    ds_read_b32 v10, v8 offset:7340
    s_waitcnt lgkmcnt(0)
    v_readfirstlane_b32 s45, v10
    s_nop 0
    s_cmp_ge_u32 s45, 4
    s_cbranch_scc1 L_lw20_ok
    s_sleep 1
    s_add_u32 s44, s44, 1
    s_cmp_lt_u32 s44, 1600000
    s_cbranch_scc1 L_lw20
L_lw20_ok:
    s_sub_u32 s40, s50, s49
    v_add_u32 v14, s40, v4
    v_cndmask_b32 v14, v14, v4, s[56:57]
    s_mov_b32 s40, 0xbdd2d3e8
    v_mov_b32 v28, 0xc0135761
    v_mov_b32 v9, 2
    s_mov_b32 s43, 0
    s_and_b32 s34, s30, 1023
    s_and_b32 s35, s31, 1023
    s_and_b32 s36, s32, 1023
    s_and_b32 s37, s33, 1023
    s_mov_b32 s46, s50
    s_mov_b32 s47, s49
    s_mov_b64 exec, s[52:53]
    buffer_load_dwordx4 v[40:43], v4, s[4:7], s46 offen sc1
    buffer_load_dwordx4 v[44:47], v14, s[4:7], s47 offen sc1
    s_mov_b32 s44, 0
L_lw22:
    ds_read_b32 v10, v8 offset:7340
    s_waitcnt lgkmcnt(0)
    v_readfirstlane_b32 s45, v10
    s_nop 0
    s_cmp_ge_u32 s45, 8
    s_cbranch_scc1 L_lw22_ok
    s_sleep 1
    s_add_u32 s44, s44, 1
    s_cmp_lt_u32 s44, 1600000
    s_cbranch_scc1 L_lw22
L_lw22_ok:
    buffer_load_dwordx4 v[48:51], v4, s[4:7], s46 offen sc1
    buffer_load_dwordx4 v[52:55], v14, s[4:7], s47 offen sc1
    s_mov_b32 s44, 0
L_lw23:
    ds_read_b32 v10, v8 offset:7340
    s_waitcnt lgkmcnt(0)
    v_readfirstlane_b32 s45, v10
    s_nop 0
    s_cmp_ge_u32 s45, 12
    s_cbranch_scc1 L_lw23_ok
    s_sleep 1
    s_add_u32 s44, s44, 1
    s_cmp_lt_u32 s44, 1600000
    s_cbranch_scc1 L_lw23
L_lw23_ok:
    buffer_load_dwordx4 v[56:59], v4, s[4:7], s46 offen sc1
    buffer_load_dwordx4 v[60:63], v14, s[4:7], s47 offen sc1
    s_mov_b32 s44, 0
L_pp21:
    s_waitcnt vmcnt(4)
    v_xor_b32 v16, s34, v40
    v_xor_b32 v17, s35, v41
    v_xor_b32 v18, s36, v42
    v_xor_b32 v19, s37, v43
    v_xor_b32 v20, s34, v44
    v_xor_b32 v21, s35, v45
    v_xor_b32 v22, s36, v46
    v_xor_b32 v23, s37, v47
    v_or3_b32 v10, v16, v17, v18
    v_or3_b32 v10, v10, v19, v20
    v_or3_b32 v10, v10, v21, v22
    v_or_b32 v10, v10, v23
    v_and_b32 v10, 1023, v10
    v_cmp_ne_u32 vcc, 0, v10
    s_nop 0
    s_and_b64 exec, vcc, exec
    s_cbranch_scc0 L_pp21_ok
    buffer_load_dwordx4 v[40:43], v4, s[4:7], s46 offen sc1
    buffer_load_dwordx4 v[44:47], v14, s[4:7], s47 offen sc1
    s_waitcnt vmcnt(4)
    v_xor_b32 v16, s34, v48
    v_xor_b32 v17, s35, v49
    v_xor_b32 v18, s36, v50
    v_xor_b32 v19, s37, v51
    v_xor_b32 v20, s34, v52
    v_xor_b32 v21, s35, v53
    v_xor_b32 v22, s36, v54
    v_xor_b32 v23, s37, v55
    v_or3_b32 v10, v16, v17, v18
    v_or3_b32 v10, v10, v19, v20
    v_or3_b32 v10, v10, v21, v22
    v_or_b32 v10, v10, v23
    v_and_b32 v10, 1023, v10
    v_cmp_ne_u32 vcc, 0, v10
    s_nop 0
    s_and_b64 exec, vcc, exec
    s_cbranch_scc0 L_pp21_ok
    buffer_load_dwordx4 v[48:51], v4, s[4:7], s46 offen sc1
    buffer_load_dwordx4 v[52:55], v14, s[4:7], s47 offen sc1
    s_waitcnt vmcnt(4)
    v_xor_b32 v16, s34, v56
    v_xor_b32 v17, s35, v57
    v_xor_b32 v18, s36, v58
    v_xor_b32 v19, s37, v59
    v_xor_b32 v20, s34, v60
    v_xor_b32 v21, s35, v61
    v_xor_b32 v22, s36, v62
    v_xor_b32 v23, s37, v63
    v_or3_b32 v10, v16, v17, v18
    v_or3_b32 v10, v10, v19, v20
    v_or3_b32 v10, v10, v21, v22
    v_or_b32 v10, v10, v23
    v_and_b32 v10, 1023, v10
    v_cmp_ne_u32 vcc, 0, v10
    s_nop 0
    s_and_b64 exec, vcc, exec
    s_cbranch_scc0 L_pp21_ok
    buffer_load_dwordx4 v[56:59], v4, s[4:7], s46 offen sc1
    buffer_load_dwordx4 v[60:63], v14, s[4:7], s47 offen sc1
    s_add_u32 s44, s44, 1
    s_and_b32 s45, s44, 1
    s_cselect_b32 s45, 786432, 0
    s_add_u32 s46, s50, s45
    s_add_u32 s47, s49, s45
    s_cmp_lt_u32 s44, 200000
    s_cbranch_scc1 L_pp21
L_pp21_ok:
    s_mov_b64 exec, -1
    s_mov_b64 exec, s[56:57]
    v_pk_add_f32 v[16:17], v[16:17], v[20:21]
    v_pk_add_f32 v[18:19], v[18:19], v[22:23]
    s_mov_b64 exec, -1
    v_permlane32_swap_b32 v16, v17
    v_permlane32_swap_b32 v18, v19
    v_add_f32 v16, v16, v17
    v_add_f32 v18, v18, v19
    s_nop 1
    v_permlane16_swap_b32 v16, v18
    v_cvt_pk_bf16_f32 v20, v16, v18
    v_lshlrev_b32 v16, 16, v20
    v_and_b32 v17, 0xffff0000, v20
    v_mul_f32 v20, v16, v16
    v_fma_f32 v20, v20, s40, v28
    v_mul_f32 v20, v20, v16
    v_exp_f32 v20, v20
    s_nop 0
    v_add_f32 v20, 1.0, v20
    v_rcp_f32 v20, v20
    s_nop 0
    v_mul_f32 v20, v20, v16
    v_cvt_pk_bf16_f32 v20, v20, v20
    v_lshlrev_b32 v20, 16, v20
    v_mul_f32 v20, v20, v17
    v_cvt_pk_bf16_f32 v20, v20, v20
    s_mov_b64 exec, s[52:53]
    ds_write_b16 v2, v20
    s_mov_b64 exec, 1
    ds_add_u32 v8, v9 offset:7332
    s_mov_b64 exec, -1
    s_branch L_fin
L_RED:
    s_load_dwordx2 s[24:25], s[0:1], 72
    s_mov_b32 s26, 2048
    s_mov_b32 s27, 0x20000
    s_lshl_b32 s52, s60, 3
    v_lshrrev_b32 v3, 5, v1
    v_bfe_u32 v5, v1, 4, 1
    v_lshl_or_b32 v3, v5, 1, v3
    v_lshlrev_b32 v3, 1, v3
    v_mov_b32 v24, 0
    buffer_load_short_d16_hi v24, v3, s[8:11], s52 offen
    v_mov_b32 v26, s38
    v_mov_b32 v27, s39
    s_lshl_b32 s53, s61, 7
    s_add_u32 s53, s53, 180224
    s_lshl_b32 s54, s62, 2
    s_add_u32 s54, s54, s53
    v_lshlrev_b32 v5, 2, v1
    s_lshr_b32 s50, s60, 3
    s_lshl_b32 s50, s50, 14
    s_and_b32 s40, s60, 7
    s_lshl_b32 s40, s40, 4
    s_add_u32 s50, s50, s40
    s_add_u32 s50, s50, 1572864
    s_add_u32 s51, s50, 8192
    v_lshlrev_b32 v2, 7, v1
    s_waitcnt lgkmcnt(0)
    s_barrier
    s_mov_b64 exec, 1
    buffer_store_dword v26, off, s[4:7], s54
    s_mov_b32 exec_lo, -1
    s_mov_b32 s44, 0
L_xf:
    buffer_load_dword v28, v5, s[4:7], s53 offen sc1
    s_add_u32 s44, s44, 1
    s_waitcnt vmcnt(0)
    v_cmp_eq_u32 vcc, s38, v28
    s_nop 0
    s_bcnt1_i32_b64 s45, vcc
    s_cmp_ge_u32 s45, 32
    s_cbranch_scc1 L_xf_ok
    s_cmp_lt_u32 s44, 16
    s_cbranch_scc1 L_xf
L_xf_ok:
    s_mov_b64 exec, -1
    s_and_b32 s34, s30, 1023
    s_and_b32 s35, s31, 1023
    s_and_b32 s36, s32, 1023
    s_and_b32 s37, s33, 1023
    s_mov_b32 s44, 0
L_poll24:
    buffer_load_dwordx4 v[16:19], v2, s[4:7], s50 offen offset:0 sc1
    buffer_load_dwordx4 v[20:23], v2, s[4:7], s51 offen offset:0 sc1
L_poll24_w:
    s_waitcnt vmcnt(0)
L_poll24_c:
    v_xor_b32 v16, s34, v16
    v_xor_b32 v17, s35, v17
    v_xor_b32 v18, s36, v18
    v_xor_b32 v19, s37, v19
    v_xor_b32 v20, s34, v20
    v_xor_b32 v21, s35, v21
    v_xor_b32 v22, s36, v22
    v_xor_b32 v23, s37, v23
    v_or3_b32 v10, v16, v17, v18
    v_or3_b32 v10, v10, v19, v20
    v_or3_b32 v10, v10, v21, v22
    v_or_b32 v10, v10, v23
    v_and_b32 v10, 1023, v10
    v_cmp_ne_u32 vcc, 0, v10
    s_nop 0
    s_and_b64 exec, vcc, exec
    s_cbranch_scc0 L_poll24_ok
    s_sleep 1
    s_add_u32 s44, s44, 1
    s_cmp_lt_u32 s44, 200000
    s_cbranch_scc1 L_poll24
L_poll24_ok:
    s_mov_b64 exec, -1
    v_permlane32_swap_b32 v16, v17
    v_permlane32_swap_b32 v18, v19
    v_permlane32_swap_b32 v20, v21
    v_permlane32_swap_b32 v22, v23
    v_add_f32 v16, v16, v17
    v_add_f32 v18, v18, v19
    v_add_f32 v20, v20, v21
    v_add_f32 v22, v22, v23
    v_permlane16_swap_b32 v16, v18
    s_nop 0
    v_permlane16_swap_b32 v20, v22
    v_add_f32 v16, v16, v18
    v_add_f32 v20, v20, v22
    s_nop 0
    v_add_f32_dpp v16, v16, v16 row_ror:8 row_mask:0xf bank_mask:0xf
    v_add_f32_dpp v20, v20, v20 row_ror:8 row_mask:0xf bank_mask:0xf
    s_nop 0
    v_add_f32_dpp v16, v16, v16 row_ror:4 row_mask:0xf bank_mask:0xf
    v_add_f32_dpp v20, v20, v20 row_ror:4 row_mask:0xf bank_mask:0xf
    s_nop 0
    v_add_f32_dpp v16, v16, v16 row_ror:2 row_mask:0xf bank_mask:0xf
    v_add_f32_dpp v20, v20, v20 row_ror:2 row_mask:0xf bank_mask:0xf
    s_nop 0
    v_add_f32_dpp v16, v16, v16 row_ror:1 row_mask:0xf bank_mask:0xf
    v_add_f32_dpp v20, v20, v20 row_ror:1 row_mask:0xf bank_mask:0xf
    v_cvt_pk_bf16_f32 v16, v16, v20
    v_lshlrev_b32 v17, 16, v16
    v_and_b32 v18, 0xffff0000, v16
    v_add_f32 v17, v17, v24
    v_cvt_pk_bf16_f32 v17, v17, v17
    v_lshlrev_b32 v17, 16, v17
    v_add_f32 v16, v17, v18
    v_cvt_pk_bf16_f32 v16, v16, v16
    s_mov_b32 exec_lo, 0x10001
    s_mov_b32 exec_hi, 0x10001
    buffer_store_short v16, v3, s[24:27], s52 offen
    s_mov_b64 exec, 1
    s_cmp_lg_u32 s60, 0
    s_cbranch_scc1 L_fin
    buffer_store_dwordx2 v[26:27], off, s[4:7], 0 sc0 sc1
    s_branch L_fin
L_fin:
L_end:
    s_endpgm
.section .rodata,"a"
.p2align 6
.amdhsa_kernel parallel_sum__sliding_block_cached__glu_gated_geglu__decode_kernel
  .amdhsa_next_free_vgpr 128
  .amdhsa_next_free_sgpr 64
  .amdhsa_accum_offset 128
  .amdhsa_group_segment_fixed_size 0
  .amdhsa_kernarg_size 96
  .amdhsa_user_sgpr_count 2
  .amdhsa_user_sgpr_kernarg_segment_ptr 1
  .amdhsa_system_sgpr_workgroup_id_x 1
.end_amdhsa_kernel
```
